```python
import torch

def _softmax(x, axis=-1):
    return torch.softmax(x, dim=axis)
def _gelu(x):
    return torch.nn.functional.gelu(x, approximate="tanh")
def _silu(x):
    return torch.nn.functional.silu(x)
def _sigmoid(x):
    return torch.sigmoid(x)
def _layernorm(x, axis=-1, eps=1e-5):
    m = x.mean(dim=axis, keepdim=True)
    v = x.var(dim=axis, keepdim=True, unbiased=False)
    return (x - m) / torch.sqrt(v + eps)
def _scatter_add(tgt, idx, src, axis=0):
    return tgt.clone().index_add_(axis, idx, src)
def _segment_sum(src, seg, n):
    out = torch.zeros((n,) + src.shape[1:], dtype=src.dtype)
    return out.index_add_(0, seg, src)
def _pad(x, pw):
    flat = tuple(v for pair in reversed(pw) for v in pair)
    return torch.nn.functional.pad(x, flat)

kernel_name = 'standalone__gqa_block_cached__sampling'

def setup_inputs():

    _w = (lambda a: (lambda t: t.to(torch.bfloat16) if t.is_floating_point() else t)(torch.as_tensor(a)))
    B, Sq, D = 16, 1, 1024
    Hq, Hkv, Sk, Dh = 32, 4, 4096, 128
    assert Hq % Hkv == 0, (Hq, Hkv)
    return {
        "x": _w((lambda *s: torch.randn(*s, dtype=torch.bfloat16) * 0.8)(B, Sq, D)),
        "k_cache": _w((lambda *s: torch.randn(*s, dtype=torch.bfloat16) * 0.8)(B, Hkv, Sk, Dh)),
        "v_cache": _w((lambda *s: torch.randn(*s, dtype=torch.bfloat16) * 0.05)(B, Hkv, Sk, Dh)),
        "wq": _w((lambda *s: torch.randn(*s, dtype=torch.bfloat16) * 0.8)(D, Hq * Dh) * (D ** -0.5)),
        "wo": _w((lambda *s: torch.randn(*s, dtype=torch.bfloat16) * 0.05)(Hq * Dh, D) * ((Hq * Dh) ** -0.5)),
    }

def reference(x, k_cache, v_cache, wq, wo):
    B, Sq, D = x.shape
    Hq, Dh = 32, 128
    Hkv = k_cache.shape[1]
    rep = Hq // Hkv
    q = (lambda x, *d: x.permute(*d))((x @ wq).reshape(B, Sq, Hq, Dh), 0, 2, 1, 3)
    k = (lambda x, n, axis: torch.repeat_interleave(x, n, dim=axis))(k_cache, rep, axis=1)
    v = (lambda x, n, axis: torch.repeat_interleave(x, n, dim=axis))(v_cache, rep, axis=1)
    scores = torch.einsum("bhqd,bhkd->bhqk", q, k) * (Dh ** -0.5)
    p = _softmax(scores, axis=-1)
    o = torch.einsum("bhqk,bhkd->bhqd", p, v)
    return (lambda x, *d: x.permute(*d))(o, 0, 2, 1, 3).reshape(B, Sq, Hq * Dh) @ wo
```

```asm
; @launch grid=(256,1,1) block=(320,1,1) lds=154528
.amdgcn_target "amdgcn-amd-amdhsa--gfx950"
.text
.globl standalone__gqa_block_cached__sampling_kernel
.p2align 8
.type standalone__gqa_block_cached__sampling_kernel,@function
standalone__gqa_block_cached__sampling_kernel:
    s_cmp_ge_u32 s2, 256
    s_cbranch_scc1 L_end
    s_load_dwordx16 s[4:19], s[0:1], 0
    v_lshrrev_b32 v24, 6, v0
    v_and_b32 v1, 63, v0
    s_and_b32 s53, s2, 7
    v_readfirstlane_b32 s52, v24
    s_lshr_b32 s54, s2, 3
    s_lshr_b32 s57, s2, 5
    s_lshl3_add_u32 s64, s53, s57
    s_add_u32 s65, s54, s57
    s_and_b32 s65, s65, 3
    v_lshrrev_b32 v25, 4, v1
    v_and_b32 v26, 15, v1
    s_cmp_eq_u32 s52, 4
    s_cbranch_scc1 L_ctrl0
    s_lshl_b32 s56, s52, 15
    s_lshl_b32 s55, s64, 20
    s_lshl_b32 s58, s52, 12
    s_cmp_eq_u32 s65, 0
    s_cbranch_scc1 L_pro_q
    v_add_u32 v29, 0, v25
    v_xor_b32 v29, v26, v29
    v_lshlrev_b32 v29, 4, v29
    v_lshl_or_b32 v2, v25, 8, v29
    v_add_u32 v29, 4, v25
    v_xor_b32 v29, v26, v29
    v_lshlrev_b32 v29, 4, v29
    v_lshl_or_b32 v3, v25, 8, v29
    v_add_u32 v29, 8, v25
    v_xor_b32 v29, v26, v29
    v_lshlrev_b32 v29, 4, v29
    v_lshl_or_b32 v4, v25, 8, v29
    v_add_u32 v29, 12, v25
    v_xor_b32 v29, v26, v29
    v_lshlrev_b32 v29, 4, v29
    v_lshl_or_b32 v5, v25, 8, v29
    s_mul_i32 s57, s65, 278528
    s_add_u32 s55, s55, s57
    s_sub_u32 s55, s55, 65536
    s_lshl1_add_u32 s98, s58, s55
    s_add_u32 s59, s98, 4096
    s_branch L_pro_j
L_pro_q:
    v_add_u32 v29, 0, v25
    v_lshlrev_b32 v29, 1, v29
    v_xor_b32 v29, v26, v29
    v_lshlrev_b32 v29, 4, v29
    v_lshl_or_b32 v2, v25, 13, v29
    v_add_u32 v29, 4, v25
    v_lshlrev_b32 v29, 1, v29
    v_xor_b32 v29, v26, v29
    v_lshlrev_b32 v29, 4, v29
    v_lshl_or_b32 v3, v25, 13, v29
    v_add_u32 v4, 129024, v2
    v_add_u32 v5, 193536, v3
    v_add_u32 v3, 64512, v3
    s_lshr_b32 s59, s2, 5
    s_add_u32 s57, s53, s59
    s_and_b32 s57, s57, 3
    s_lshl_b32 s57, s57, 3
    s_add_u32 s57, s57, s59
    s_lshr_b32 s59, s53, 2
    s_lshl4_add_u32 s66, s59, s52
    s_lshl_b32 s98, s66, 18
    s_lshl_b32 s57, s57, 8
    s_add_u32 s98, s98, s57
    s_add_u32 s59, s98, 32768
L_pro_j:
    s_add_u32 s97, s55, s58
    s_add_u32 s55, s97, s58
    s_mov_b32 m0, s56
    s_mov_b32 s23, 0x20000
    s_cmp_eq_u32 s65, 0
    s_mov_b32 s57, 0x4000000
    s_cselect_b32 s22, 0x800000, s57
    s_waitcnt lgkmcnt(0)
    s_cselect_b32 s20, s10, s6
    s_cselect_b32 s21, s11, s7
    buffer_load_dwordx4 v2, s[20:23], s98 offen offset:0 nt lds
    buffer_load_dwordx4 v3, s[20:23], s98 offen offset:1024 nt lds
    buffer_load_dwordx4 v4, s[20:23], s98 offen offset:2048 nt lds
    buffer_load_dwordx4 v5, s[20:23], s98 offen offset:3072 nt lds
    s_add_u32 m0, s56, 4096
    s_mov_b32 s61, s59
    buffer_load_dwordx4 v2, s[20:23], s61 offen offset:0 nt lds
    s_cmp_eq_u32 s65, 0
    s_cbranch_scc1 L_qwg
    s_branch L_nwg
L_ctrl0:
    s_setprio 3
    s_getpc_b64 s[70:71]
L_pc:
    v_lshl_add_u32 v22, v1, 5, s54
    v_lshlrev_b32 v22, 7, v22
    v_cmp_gt_u32 vcc, L_last-L_pc, v22
    s_mov_b64 exec, vcc
    global_load_dword v23, v22, s[70:71]
    s_mov_b64 exec, -1
    v_mov_b32 v31, 154496
    v_mov_b32 v8, 0
    v_mov_b32 v9, 0
    v_mov_b32 v10, 0
    v_mov_b32 v11, 0
    ds_write_b128 v31, v[8:11]
    ds_write_b128 v31, v[8:11] offset:16
    s_waitcnt lgkmcnt(0)
    s_mov_b32 s40, s18
    s_mov_b32 s41, s19
    s_mov_b32 s42, 0x10000000
    s_mov_b32 s43, 0x20000
    s_mov_b32 s57, 2392064
    buffer_load_dword v8, v9, s[40:43], s57 offen sc1
    s_barrier
    s_branch L_ctrl
L_nwg:
    s_barrier
    s_mov_b32 s24, s8
    s_mov_b32 s25, s9
    s_mov_b32 s26, 0x4000000
    s_mov_b32 s27, 0x20000
    s_mov_b32 s32, s12
    s_mov_b32 s33, s13
    s_mov_b32 s34, 0x800000
    s_mov_b32 s35, 0x20000
    s_mov_b32 s40, s18
    s_mov_b32 s41, s19
    s_mov_b32 s42, 0x10000000
    s_mov_b32 s43, 0x20000
    s_mov_b32 s44, s14
    s_mov_b32 s45, s15
    s_mov_b32 s46, 0x8000
    s_mov_b32 s47, 0x20000
    s_mov_b32 s63, 0
    s_mov_b32 s16, 0
    s_mov_b32 s62, 0x3e0293ee
    v_add_u32 v29, 0, v25
    v_lshlrev_b32 v29, 1, v29
    v_xor_b32 v29, v26, v29
    v_lshlrev_b32 v29, 4, v29
    v_lshl_or_b32 v6, v25, 8, v29
    v_add_u32 v29, 4, v25
    v_lshlrev_b32 v29, 1, v29
    v_xor_b32 v29, v26, v29
    v_lshlrev_b32 v29, 4, v29
    v_lshl_or_b32 v7, v25, 8, v29
    v_add_u32 v29, 0, v25
    v_xor_b32 v29, v26, v29
    v_lshlrev_b32 v29, 4, v29
    v_lshl_or_b32 v29, v26, 8, v29
    v_add_u32 v8, s56, v29
    v_add_u32 v29, 4, v25
    v_xor_b32 v29, v26, v29
    v_lshlrev_b32 v29, 4, v29
    v_lshl_or_b32 v29, v26, 8, v29
    v_add_u32 v9, s56, v29
    v_add_u32 v29, 8, v25
    v_xor_b32 v29, v26, v29
    v_lshlrev_b32 v29, 4, v29
    v_lshl_or_b32 v29, v26, 8, v29
    v_add_u32 v10, s56, v29
    v_add_u32 v29, 12, v25
    v_xor_b32 v29, v26, v29
    v_lshlrev_b32 v29, 4, v29
    v_lshl_or_b32 v29, v26, 8, v29
    v_add_u32 v11, s56, v29
    v_lshrrev_b32 v30, 2, v1
    v_and_b32 v31, 3, v1
    v_lshlrev_b32 v24, 3, v31
    v_lshl_or_b32 v24, v30, 8, v24
    v_add_u32 v24, s56, v24
    v_and_b32 v29, 7, v30
    v_xor_b32 v28, 0, v29
    v_lshl_add_u32 v12, v28, 5, v24
    v_xor_b32 v28, 1, v29
    v_lshl_add_u32 v13, v28, 5, v24
    v_xor_b32 v28, 2, v29
    v_lshl_add_u32 v14, v28, 5, v24
    v_xor_b32 v28, 3, v29
    v_lshl_add_u32 v15, v28, 5, v24
    v_xor_b32 v28, 4, v29
    v_lshl_add_u32 v16, v28, 5, v24
    v_xor_b32 v28, 5, v29
    v_lshl_add_u32 v17, v28, 5, v24
    v_xor_b32 v28, 6, v29
    v_lshl_add_u32 v18, v28, 5, v24
    v_xor_b32 v28, 7, v29
    v_lshl_add_u32 v19, v28, 5, v24
    s_lshl_b32 s58, s54, 18
    s_lshl_b32 s59, s52, 16
    s_add_u32 s58, s58, s59
    s_lshl_b32 s59, s53, 8
    s_add_u32 s96, s58, s59
    v_lshlrev_b32 v27, 2, v25
    v_xor_b32 v27, v26, v27
    v_lshlrev_b32 v27, 4, v27
    v_lshl_or_b32 v20, v25, 11, v27
    v_and_b32 v29, 3, v30
    v_lshlrev_b32 v29, 2, v29
    s_lshl_b32 s57, s52, 2
    v_add_u32 v28, s57, v31
    v_xor_b32 v28, v28, v29
    v_lshlrev_b32 v28, 4, v28
    v_lshl_or_b32 v28, v30, 8, v28
    v_add_u32 v21, 24576, v28
    v_and_b32 v28, 7, v1
    v_lshlrev_b32 v27, 4, v25
    v_lshl_or_b32 v28, v28, 8, v27
    v_add_u32 v30, 147968, v28
    v_mov_b32 v31, 154496
    s_waitcnt vmcnt(4)
    buffer_load_dwordx4 v3, s[20:23], s61 offen offset:1024 nt lds
    s_waitcnt vmcnt(4)
    buffer_load_dwordx4 v4, s[20:23], s61 offen offset:2048 nt lds
    s_waitcnt vmcnt(4)
    buffer_load_dwordx4 v5, s[20:23], s61 offen offset:3072 nt lds
    s_waitcnt vmcnt(4)
    s_add_u32 m0, s56, 8192
    s_add_u32 s61, s55, 32768
    buffer_load_dwordx4 v2, s[20:23], s61 offen offset:0 nt lds
    s_waitcnt vmcnt(4)
    buffer_load_dwordx4 v3, s[20:23], s61 offen offset:1024 nt lds
    s_waitcnt vmcnt(4)
    buffer_load_dwordx4 v4, s[20:23], s61 offen offset:2048 nt lds
    s_waitcnt vmcnt(4)
    buffer_load_dwordx4 v5, s[20:23], s61 offen offset:3072 nt lds
    s_waitcnt vmcnt(4)
    s_add_u32 m0, s56, 12288
    s_add_u32 s61, s55, 36864
    buffer_load_dwordx4 v2, s[20:23], s61 offen offset:0 nt lds
    ds_read_b32 v28, v31 offset:20
    ds_read_b128 v[64:67], v8 offset:0
    ds_read_b128 v[68:71], v9 offset:0
    ds_read_b128 v[72:75], v10 offset:0
    ds_read_b128 v[76:79], v11 offset:0
    ds_read_b128 v[80:83], v8 offset:4096
    ds_read_b128 v[84:87], v9 offset:4096
    ds_read_b128 v[88:91], v10 offset:4096
    ds_read_b128 v[92:95], v11 offset:4096
    s_waitcnt lgkmcnt(0)
    v_readfirstlane_b32 s16, v28
    s_waitcnt vmcnt(4)
    buffer_load_dwordx4 v3, s[20:23], s61 offen offset:1024 nt lds
    s_waitcnt vmcnt(4)
    buffer_load_dwordx4 v4, s[20:23], s61 offen offset:2048 nt lds
    s_waitcnt vmcnt(4)
    buffer_load_dwordx4 v5, s[20:23], s61 offen offset:3072 nt lds
    s_waitcnt vmcnt(4)
    s_add_u32 m0, s56, 0
    s_add_u32 s61, s55, 65536
    buffer_load_dwordx4 v2, s[20:23], s61 offen offset:0 nt lds
    s_waitcnt vmcnt(4)
    buffer_load_dwordx4 v3, s[20:23], s61 offen offset:1024 nt lds
    s_waitcnt vmcnt(4)
    buffer_load_dwordx4 v4, s[20:23], s61 offen offset:2048 nt lds
    s_waitcnt vmcnt(4)
    buffer_load_dwordx4 v5, s[20:23], s61 offen offset:3072 nt lds
    s_waitcnt vmcnt(4)
    s_add_u32 m0, s56, 4096
    s_add_u32 s61, s55, 69632
    buffer_load_dwordx4 v2, s[20:23], s61 offen offset:0 nt lds
    ds_read_b32 v28, v31 offset:20
    ds_read_b128 v[96:99], v8 offset:8192
    ds_read_b128 v[100:103], v9 offset:8192
    ds_read_b128 v[104:107], v10 offset:8192
    ds_read_b128 v[108:111], v11 offset:8192
    ds_read_b128 v[112:115], v8 offset:12288
    ds_read_b128 v[116:119], v9 offset:12288
    ds_read_b128 v[120:123], v10 offset:12288
    ds_read_b128 v[124:127], v11 offset:12288
    s_waitcnt lgkmcnt(0)
    v_readfirstlane_b32 s16, v28
    s_waitcnt vmcnt(4)
    buffer_load_dwordx4 v3, s[20:23], s61 offen offset:1024 nt lds
    s_waitcnt vmcnt(4)
    buffer_load_dwordx4 v4, s[20:23], s61 offen offset:2048 nt lds
    s_waitcnt vmcnt(4)
    buffer_load_dwordx4 v5, s[20:23], s61 offen offset:3072 nt lds
    s_cmp_ge_u32 s16, 1
    s_cbranch_scc1 L_sn24
    s_waitcnt vmcnt(4)
L_sn24:
    s_add_u32 m0, s56, 8192
    s_add_u32 s61, s55, 98304
    buffer_load_dwordx4 v2, s[20:23], s61 offen offset:0 nt lds
    s_cmp_ge_u32 s16, 2
    s_cbranch_scc1 L_sn25
    s_waitcnt vmcnt(5)
    s_cmp_ge_u32 s16, 1
    s_cbranch_scc1 L_sn25
    s_waitcnt vmcnt(4)
L_sn25:
    buffer_load_dwordx4 v3, s[20:23], s61 offen offset:1024 nt lds
    s_waitcnt vmcnt(6)
    s_cmp_ge_u32 s16, 2
    s_cbranch_scc1 L_sn26
    s_waitcnt vmcnt(5)
    s_cmp_ge_u32 s16, 1
    s_cbranch_scc1 L_sn26
    s_waitcnt vmcnt(4)
L_sn26:
    buffer_load_dwordx4 v4, s[20:23], s61 offen offset:2048 nt lds
    s_waitcnt vmcnt(6)
    s_cmp_ge_u32 s16, 2
    s_cbranch_scc1 L_sn27
    s_waitcnt vmcnt(5)
    s_cmp_ge_u32 s16, 1
    s_cbranch_scc1 L_sn27
    s_waitcnt vmcnt(4)
L_sn27:
    buffer_load_dwordx4 v5, s[20:23], s61 offen offset:3072 nt lds
    s_waitcnt vmcnt(6)
    s_cmp_ge_u32 s16, 2
    s_cbranch_scc1 L_sn28
    s_waitcnt vmcnt(5)
    s_cmp_ge_u32 s16, 1
    s_cbranch_scc1 L_sn28
    s_waitcnt vmcnt(4)
L_sn28:
    s_add_u32 m0, s56, 12288
    s_add_u32 s61, s55, 102400
    buffer_load_dwordx4 v2, s[20:23], s61 offen offset:0 nt lds
    s_waitcnt vmcnt(6)
    s_cmp_ge_u32 s16, 2
    s_cbranch_scc1 L_sn29
    s_waitcnt vmcnt(5)
    s_cmp_ge_u32 s16, 1
    s_cbranch_scc1 L_sn29
    s_waitcnt vmcnt(4)
L_sn29:
    buffer_load_dwordx4 v3, s[20:23], s61 offen offset:1024 nt lds
    s_waitcnt vmcnt(6)
    s_cmp_ge_u32 s16, 2
    s_cbranch_scc1 L_sn30
    s_waitcnt vmcnt(5)
    s_cmp_ge_u32 s16, 1
    s_cbranch_scc1 L_sn30
    s_waitcnt vmcnt(4)
L_sn30:
    buffer_load_dwordx4 v4, s[20:23], s61 offen offset:2048 nt lds
    ds_read_b32 v28, v31 offset:20
    ds_read_b128 v[128:131], v8 offset:0
    ds_read_b128 v[132:135], v9 offset:0
    ds_read_b128 v[136:139], v10 offset:0
    ds_read_b128 v[140:143], v11 offset:0
    ds_read_b128 v[144:147], v8 offset:4096
    ds_read_b128 v[148:151], v9 offset:4096
    ds_read_b128 v[152:155], v10 offset:4096
    ds_read_b128 v[156:159], v11 offset:4096
    s_waitcnt lgkmcnt(0)
    v_readfirstlane_b32 s16, v28
    s_waitcnt vmcnt(6)
    s_cmp_ge_u32 s16, 2
    s_cbranch_scc1 L_sn31
    s_waitcnt vmcnt(5)
    s_cmp_ge_u32 s16, 1
    s_cbranch_scc1 L_sn31
    s_waitcnt vmcnt(4)
L_sn31:
    buffer_load_dwordx4 v5, s[20:23], s61 offen offset:3072 nt lds
    v_mov_b32 v29, 1
    s_mov_b64 exec, 1
    ds_add_u32 v31, v29 offset:8
    s_mov_b64 exec, -1
    s_waitcnt vmcnt(6)
    s_cmp_ge_u32 s16, 2
    s_cbranch_scc1 L_sn32
    s_waitcnt vmcnt(5)
    s_cmp_ge_u32 s16, 1
    s_cbranch_scc1 L_sn32
    s_waitcnt vmcnt(4)
L_sn32:
    s_add_u32 m0, s56, 0
    s_add_u32 s61, s55, 131072
    buffer_load_dwordx4 v2, s[20:23], s61 offen offset:0 nt lds
    s_waitcnt vmcnt(6)
    s_cmp_ge_u32 s16, 2
    s_cbranch_scc1 L_sn33
    s_waitcnt vmcnt(5)
    s_cmp_ge_u32 s16, 1
    s_cbranch_scc1 L_sn33
    s_waitcnt vmcnt(4)
L_sn33:
    buffer_load_dwordx4 v3, s[20:23], s61 offen offset:1024 nt lds
    s_waitcnt vmcnt(6)
    s_cmp_ge_u32 s16, 2
    s_cbranch_scc1 L_sn34
    s_waitcnt vmcnt(5)
    s_cmp_ge_u32 s16, 1
    s_cbranch_scc1 L_sn34
    s_waitcnt vmcnt(4)
L_sn34:
    buffer_load_dwordx4 v4, s[20:23], s61 offen offset:2048 nt lds
    s_waitcnt vmcnt(6)
    s_cmp_ge_u32 s16, 2
    s_cbranch_scc1 L_sn35
    s_waitcnt vmcnt(5)
    s_cmp_ge_u32 s16, 1
    s_cbranch_scc1 L_sn35
    s_waitcnt vmcnt(4)
L_sn35:
    buffer_load_dwordx4 v5, s[20:23], s61 offen offset:3072 nt lds
    s_waitcnt vmcnt(6)
    s_cmp_ge_u32 s16, 2
    s_cbranch_scc1 L_sn36
    s_waitcnt vmcnt(5)
    s_cmp_ge_u32 s16, 1
    s_cbranch_scc1 L_sn36
    s_waitcnt vmcnt(4)
L_sn36:
    s_add_u32 m0, s56, 4096
    s_add_u32 s61, s55, 135168
    buffer_load_dwordx4 v2, s[20:23], s61 offen offset:0 nt lds
    s_waitcnt vmcnt(6)
    s_cmp_ge_u32 s16, 2
    s_cbranch_scc1 L_sn37
    s_waitcnt vmcnt(5)
    s_cmp_ge_u32 s16, 1
    s_cbranch_scc1 L_sn37
    s_waitcnt vmcnt(4)
L_sn37:
    buffer_load_dwordx4 v3, s[20:23], s61 offen offset:1024 nt lds
    s_waitcnt vmcnt(6)
    s_cmp_ge_u32 s16, 2
    s_cbranch_scc1 L_sn38
    s_waitcnt vmcnt(5)
    s_cmp_ge_u32 s16, 1
    s_cbranch_scc1 L_sn38
    s_waitcnt vmcnt(4)
L_sn38:
    buffer_load_dwordx4 v4, s[20:23], s61 offen offset:2048 nt lds
    ds_read_b32 v28, v31 offset:20
    ds_read_b128 v[160:163], v8 offset:8192
    ds_read_b128 v[164:167], v9 offset:8192
    ds_read_b128 v[168:171], v10 offset:8192
    ds_read_b128 v[172:175], v11 offset:8192
    ds_read_b128 v[176:179], v8 offset:12288
    ds_read_b128 v[180:183], v9 offset:12288
    ds_read_b128 v[184:187], v10 offset:12288
    ds_read_b128 v[188:191], v11 offset:12288
    s_waitcnt lgkmcnt(0)
    v_readfirstlane_b32 s16, v28
    s_waitcnt vmcnt(6)
    s_cmp_ge_u32 s16, 2
    s_cbranch_scc1 L_sn39
    s_waitcnt vmcnt(5)
    s_cmp_ge_u32 s16, 1
    s_cbranch_scc1 L_sn39
    s_waitcnt vmcnt(4)
L_sn39:
    buffer_load_dwordx4 v5, s[20:23], s61 offen offset:3072 nt lds
    s_waitcnt vmcnt(6)
    s_cmp_ge_u32 s16, 2
    s_cbranch_scc1 L_sn40
    s_waitcnt vmcnt(5)
    s_cmp_ge_u32 s16, 1
    s_cbranch_scc1 L_sn40
    s_waitcnt vmcnt(4)
L_sn40:
    s_add_u32 m0, s56, 8192
    s_add_u32 s61, s55, 163840
    buffer_load_dwordx4 v2, s[20:23], s61 offen offset:0 nt lds
    s_waitcnt vmcnt(6)
    s_cmp_ge_u32 s16, 2
    s_cbranch_scc1 L_sn41
    s_waitcnt vmcnt(5)
    s_cmp_ge_u32 s16, 1
    s_cbranch_scc1 L_sn41
    s_waitcnt vmcnt(4)
L_sn41:
    buffer_load_dwordx4 v3, s[20:23], s61 offen offset:1024 nt lds
    s_waitcnt vmcnt(6)
    s_cmp_ge_u32 s16, 2
    s_cbranch_scc1 L_sn42
    s_waitcnt vmcnt(5)
    s_cmp_ge_u32 s16, 1
    s_cbranch_scc1 L_sn42
    s_waitcnt vmcnt(4)
L_sn42:
    buffer_load_dwordx4 v4, s[20:23], s61 offen offset:2048 nt lds
    s_waitcnt vmcnt(6)
    s_cmp_ge_u32 s16, 2
    s_cbranch_scc1 L_sn43
    s_waitcnt vmcnt(5)
    s_cmp_ge_u32 s16, 1
    s_cbranch_scc1 L_sn43
    s_waitcnt vmcnt(4)
L_sn43:
    buffer_load_dwordx4 v5, s[20:23], s61 offen offset:3072 nt lds
    s_waitcnt vmcnt(6)
    s_cmp_ge_u32 s16, 2
    s_cbranch_scc1 L_sn44
    s_waitcnt vmcnt(5)
    s_cmp_ge_u32 s16, 1
    s_cbranch_scc1 L_sn44
    s_waitcnt vmcnt(4)
L_sn44:
    s_add_u32 m0, s56, 12288
    s_add_u32 s61, s55, 167936
    buffer_load_dwordx4 v2, s[20:23], s61 offen offset:0 nt lds
    s_waitcnt vmcnt(6)
    s_cmp_ge_u32 s16, 2
    s_cbranch_scc1 L_sn45
    s_waitcnt vmcnt(5)
    s_cmp_ge_u32 s16, 1
    s_cbranch_scc1 L_sn45
    s_waitcnt vmcnt(4)
L_sn45:
    buffer_load_dwordx4 v3, s[20:23], s61 offen offset:1024 nt lds
    s_waitcnt vmcnt(6)
    s_cmp_ge_u32 s16, 2
    s_cbranch_scc1 L_sn46
    s_waitcnt vmcnt(5)
    s_cmp_ge_u32 s16, 1
    s_cbranch_scc1 L_sn46
    s_waitcnt vmcnt(4)
L_sn46:
    buffer_load_dwordx4 v4, s[20:23], s61 offen offset:2048 nt lds
    ds_read_b32 v28, v31 offset:20
    ds_read_b128 v[192:195], v8 offset:0
    ds_read_b128 v[196:199], v9 offset:0
    ds_read_b128 v[200:203], v10 offset:0
    ds_read_b128 v[204:207], v11 offset:0
    ds_read_b128 v[208:211], v8 offset:4096
    ds_read_b128 v[212:215], v9 offset:4096
    ds_read_b128 v[216:219], v10 offset:4096
    ds_read_b128 v[220:223], v11 offset:4096
    s_waitcnt lgkmcnt(0)
    v_readfirstlane_b32 s16, v28
    s_waitcnt vmcnt(6)
    s_cmp_ge_u32 s16, 2
    s_cbranch_scc1 L_sn47
    s_waitcnt vmcnt(5)
    s_cmp_ge_u32 s16, 1
    s_cbranch_scc1 L_sn47
    s_waitcnt vmcnt(4)
L_sn47:
    buffer_load_dwordx4 v5, s[20:23], s61 offen offset:3072 nt lds
    s_waitcnt vmcnt(6)
    s_cmp_ge_u32 s16, 2
    s_cbranch_scc1 L_sn48
    s_waitcnt vmcnt(5)
    s_cmp_ge_u32 s16, 1
    s_cbranch_scc1 L_sn48
    s_waitcnt vmcnt(4)
L_sn48:
    s_add_u32 m0, s56, 0
    s_add_u32 s61, s55, 196608
    buffer_load_dwordx4 v2, s[20:23], s61 offen offset:0 nt lds
    s_waitcnt vmcnt(6)
    s_cmp_ge_u32 s16, 2
    s_cbranch_scc1 L_sn49
    s_waitcnt vmcnt(5)
    s_cmp_ge_u32 s16, 1
    s_cbranch_scc1 L_sn49
    s_waitcnt vmcnt(4)
L_sn49:
    buffer_load_dwordx4 v3, s[20:23], s61 offen offset:1024 nt lds
    s_waitcnt vmcnt(6)
    s_cmp_ge_u32 s16, 2
    s_cbranch_scc1 L_sn50
    s_waitcnt vmcnt(5)
    s_cmp_ge_u32 s16, 1
    s_cbranch_scc1 L_sn50
    s_waitcnt vmcnt(4)
L_sn50:
    buffer_load_dwordx4 v4, s[20:23], s61 offen offset:2048 nt lds
    s_waitcnt vmcnt(6)
    s_cmp_ge_u32 s16, 2
    s_cbranch_scc1 L_sn51
    s_waitcnt vmcnt(5)
    s_cmp_ge_u32 s16, 1
    s_cbranch_scc1 L_sn51
    s_waitcnt vmcnt(4)
L_sn51:
    buffer_load_dwordx4 v5, s[20:23], s61 offen offset:3072 nt lds
    s_waitcnt vmcnt(6)
    s_cmp_ge_u32 s16, 2
    s_cbranch_scc1 L_sn52
    s_waitcnt vmcnt(5)
    s_cmp_ge_u32 s16, 1
    s_cbranch_scc1 L_sn52
    s_waitcnt vmcnt(4)
L_sn52:
    s_add_u32 m0, s56, 4096
    s_add_u32 s61, s55, 200704
    buffer_load_dwordx4 v2, s[20:23], s61 offen offset:0 nt lds
    s_waitcnt vmcnt(6)
    s_cmp_ge_u32 s16, 2
    s_cbranch_scc1 L_sn53
    s_waitcnt vmcnt(5)
    s_cmp_ge_u32 s16, 1
    s_cbranch_scc1 L_sn53
    s_waitcnt vmcnt(4)
L_sn53:
    buffer_load_dwordx4 v3, s[20:23], s61 offen offset:1024 nt lds
    s_waitcnt vmcnt(6)
    s_cmp_ge_u32 s16, 2
    s_cbranch_scc1 L_sn54
    s_waitcnt vmcnt(5)
    s_cmp_ge_u32 s16, 1
    s_cbranch_scc1 L_sn54
    s_waitcnt vmcnt(4)
L_sn54:
    buffer_load_dwordx4 v4, s[20:23], s61 offen offset:2048 nt lds
    ds_read_b32 v28, v31 offset:20
    ds_read_b128 v[224:227], v8 offset:8192
    ds_read_b128 v[228:231], v9 offset:8192
    ds_read_b128 v[232:235], v10 offset:8192
    ds_read_b128 v[236:239], v11 offset:8192
    ds_read_b128 v[240:243], v8 offset:12288
    ds_read_b128 v[244:247], v9 offset:12288
    ds_read_b128 v[248:251], v10 offset:12288
    ds_read_b128 v[252:255], v11 offset:12288
    s_waitcnt lgkmcnt(0)
    v_readfirstlane_b32 s16, v28
    s_waitcnt vmcnt(6)
    s_cmp_ge_u32 s16, 2
    s_cbranch_scc1 L_sn55
    s_waitcnt vmcnt(5)
    s_cmp_ge_u32 s16, 1
    s_cbranch_scc1 L_sn55
    s_waitcnt vmcnt(4)
L_sn55:
    buffer_load_dwordx4 v5, s[20:23], s61 offen offset:3072 nt lds
    s_waitcnt vmcnt(6)
    s_cmp_ge_u32 s16, 2
    s_cbranch_scc1 L_sn56
    s_waitcnt vmcnt(5)
    s_cmp_ge_u32 s16, 1
    s_cbranch_scc1 L_sn56
    s_waitcnt vmcnt(4)
L_sn56:
    s_add_u32 m0, s56, 8192
    s_add_u32 s61, s55, 229376
    buffer_load_dwordx4 v2, s[20:23], s61 offen offset:0 nt lds
    v_mov_b32 v29, 1
    s_mov_b64 exec, 1
    ds_add_u32 v31, v29 offset:8
    s_mov_b64 exec, -1
    s_waitcnt vmcnt(6)
    s_cmp_ge_u32 s16, 2
    s_cbranch_scc1 L_sn57
    s_waitcnt vmcnt(5)
    s_cmp_ge_u32 s16, 1
    s_cbranch_scc1 L_sn57
    s_waitcnt vmcnt(4)
L_sn57:
    buffer_load_dwordx4 v3, s[20:23], s61 offen offset:1024 nt lds
    s_waitcnt vmcnt(6)
    s_cmp_ge_u32 s16, 2
    s_cbranch_scc1 L_sn58
    s_waitcnt vmcnt(5)
    s_cmp_ge_u32 s16, 1
    s_cbranch_scc1 L_sn58
    s_waitcnt vmcnt(4)
L_sn58:
    buffer_load_dwordx4 v4, s[20:23], s61 offen offset:2048 nt lds
    s_waitcnt vmcnt(6)
    s_cmp_ge_u32 s16, 2
    s_cbranch_scc1 L_sn59
    s_waitcnt vmcnt(5)
    s_cmp_ge_u32 s16, 1
    s_cbranch_scc1 L_sn59
    s_waitcnt vmcnt(4)
L_sn59:
    buffer_load_dwordx4 v5, s[20:23], s61 offen offset:3072 nt lds
    s_waitcnt vmcnt(6)
    s_cmp_ge_u32 s16, 2
    s_cbranch_scc1 L_sn60
    s_waitcnt vmcnt(5)
    s_cmp_ge_u32 s16, 1
    s_cbranch_scc1 L_sn60
    s_waitcnt vmcnt(4)
L_sn60:
    s_add_u32 m0, s56, 12288
    s_add_u32 s61, s55, 233472
    buffer_load_dwordx4 v2, s[20:23], s61 offen offset:0 nt lds
    s_waitcnt vmcnt(6)
    s_cmp_ge_u32 s16, 2
    s_cbranch_scc1 L_sn61
    s_waitcnt vmcnt(5)
    s_cmp_ge_u32 s16, 1
    s_cbranch_scc1 L_sn61
    s_waitcnt vmcnt(4)
L_sn61:
    buffer_load_dwordx4 v3, s[20:23], s61 offen offset:1024 nt lds
    s_waitcnt vmcnt(6)
    s_cmp_ge_u32 s16, 2
    s_cbranch_scc1 L_sn62
    s_waitcnt vmcnt(5)
    s_cmp_ge_u32 s16, 1
    s_cbranch_scc1 L_sn62
    s_waitcnt vmcnt(4)
L_sn62:
    buffer_load_dwordx4 v4, s[20:23], s61 offen offset:2048 nt lds
    s_waitcnt vmcnt(6)
    s_cmp_ge_u32 s16, 2
    s_cbranch_scc1 L_sn63
    s_waitcnt vmcnt(5)
    s_cmp_ge_u32 s16, 1
    s_cbranch_scc1 L_sn63
    s_waitcnt vmcnt(4)
L_sn63:
    buffer_load_dwordx4 v5, s[20:23], s61 offen offset:3072 nt lds
    s_waitcnt vmcnt(6)
    s_cmp_ge_u32 s16, 2
    s_cbranch_scc1 L_sn64
    s_waitcnt vmcnt(5)
    s_cmp_ge_u32 s16, 1
    s_cbranch_scc1 L_sn64
    s_waitcnt vmcnt(4)
L_sn64:
    s_add_u32 m0, s56, 16384
    s_add_u32 s61, s97, 262144
    buffer_load_dwordx4 v2, s[20:23], s61 offen offset:0 nt lds
    s_waitcnt vmcnt(6)
    s_cmp_ge_u32 s16, 2
    s_cbranch_scc1 L_sn65
    s_waitcnt vmcnt(5)
    s_cmp_ge_u32 s16, 1
    s_cbranch_scc1 L_sn65
    s_waitcnt vmcnt(4)
L_sn65:
    buffer_load_dwordx4 v3, s[20:23], s61 offen offset:1024 nt lds
    s_waitcnt vmcnt(6)
    s_cmp_ge_u32 s16, 2
    s_cbranch_scc1 L_sn66
    s_waitcnt vmcnt(5)
    s_cmp_ge_u32 s16, 1
    s_cbranch_scc1 L_sn66
    s_waitcnt vmcnt(4)
L_sn66:
    buffer_load_dwordx4 v4, s[20:23], s61 offen offset:2048 nt lds
    s_waitcnt vmcnt(6)
    s_cmp_ge_u32 s16, 2
    s_cbranch_scc1 L_sn67
    s_waitcnt vmcnt(5)
    s_cmp_ge_u32 s16, 1
    s_cbranch_scc1 L_sn67
    s_waitcnt vmcnt(4)
L_sn67:
    buffer_load_dwordx4 v5, s[20:23], s61 offen offset:3072 nt lds
    s_waitcnt vmcnt(6)
    s_cmp_ge_u32 s16, 2
    s_cbranch_scc1 L_sn68
    s_waitcnt vmcnt(5)
    s_cmp_ge_u32 s16, 1
    s_cbranch_scc1 L_sn68
    s_waitcnt vmcnt(4)
L_sn68:
    s_add_u32 m0, s56, 20480
    s_add_u32 s61, s55, 0
    buffer_load_dwordx4 v6, s[24:27], s61 offen offset:0 nt lds
    s_waitcnt vmcnt(6)
    s_cmp_ge_u32 s16, 2
    s_cbranch_scc1 L_sn69
    s_waitcnt vmcnt(5)
    s_cmp_ge_u32 s16, 1
    s_cbranch_scc1 L_sn69
    s_waitcnt vmcnt(4)
L_sn69:
    buffer_load_dwordx4 v7, s[24:27], s61 offen offset:1024 nt lds
    s_waitcnt vmcnt(6)
    s_cmp_ge_u32 s16, 2
    s_cbranch_scc1 L_sn70
    s_waitcnt vmcnt(5)
    s_cmp_ge_u32 s16, 1
    s_cbranch_scc1 L_sn70
    s_waitcnt vmcnt(4)
L_sn70:
    buffer_load_dwordx4 v6, s[24:27], s61 offen offset:2048 nt lds
    s_waitcnt vmcnt(6)
    s_cmp_ge_u32 s16, 2
    s_cbranch_scc1 L_sn71
    s_waitcnt vmcnt(5)
    s_cmp_ge_u32 s16, 1
    s_cbranch_scc1 L_sn71
    s_waitcnt vmcnt(4)
L_sn71:
    buffer_load_dwordx4 v7, s[24:27], s61 offen offset:3072 nt lds
    s_waitcnt vmcnt(6)
    s_cmp_ge_u32 s16, 2
    s_cbranch_scc1 L_sn72
    s_waitcnt vmcnt(5)
    s_cmp_ge_u32 s16, 1
    s_cbranch_scc1 L_sn72
    s_waitcnt vmcnt(4)
L_sn72:
    s_add_u32 m0, s56, 24576
    s_add_u32 s61, s55, 4096
    buffer_load_dwordx4 v6, s[24:27], s61 offen offset:0 nt lds
    s_waitcnt vmcnt(6)
    s_cmp_ge_u32 s16, 2
    s_cbranch_scc1 L_sn73
    s_waitcnt vmcnt(5)
    s_cmp_ge_u32 s16, 1
    s_cbranch_scc1 L_sn73
    s_waitcnt vmcnt(4)
L_sn73:
    buffer_load_dwordx4 v7, s[24:27], s61 offen offset:1024 nt lds
    s_waitcnt vmcnt(6)
    s_cmp_ge_u32 s16, 2
    s_cbranch_scc1 L_sn74
    s_waitcnt vmcnt(5)
    s_cmp_ge_u32 s16, 1
    s_cbranch_scc1 L_sn74
    s_waitcnt vmcnt(4)
L_sn74:
    buffer_load_dwordx4 v6, s[24:27], s61 offen offset:2048 nt lds
    s_waitcnt vmcnt(6)
    s_cmp_ge_u32 s16, 2
    s_cbranch_scc1 L_sn75
    s_waitcnt vmcnt(5)
    s_cmp_ge_u32 s16, 1
    s_cbranch_scc1 L_sn75
    s_waitcnt vmcnt(4)
L_sn75:
    buffer_load_dwordx4 v7, s[24:27], s61 offen offset:3072 nt lds
    v_mov_b32 v29, 1
    s_mov_b64 exec, 1
    ds_add_u32 v31, v29 offset:8
    s_mov_b64 exec, -1
    s_waitcnt vmcnt(6)
    s_cmp_ge_u32 s16, 2
    s_cbranch_scc1 L_sn76
    s_waitcnt vmcnt(5)
    s_cmp_ge_u32 s16, 1
    s_cbranch_scc1 L_sn76
    s_waitcnt vmcnt(4)
L_sn76:
    s_add_u32 m0, s56, 28672
    s_add_u32 s61, s55, 32768
    buffer_load_dwordx4 v6, s[24:27], s61 offen offset:0 nt lds
    s_waitcnt vmcnt(6)
    s_cmp_ge_u32 s16, 2
    s_cbranch_scc1 L_sn77
    s_waitcnt vmcnt(5)
    s_cmp_ge_u32 s16, 1
    s_cbranch_scc1 L_sn77
    s_waitcnt vmcnt(4)
L_sn77:
    buffer_load_dwordx4 v7, s[24:27], s61 offen offset:1024 nt lds
    s_waitcnt vmcnt(6)
    s_cmp_ge_u32 s16, 2
    s_cbranch_scc1 L_sn78
    s_waitcnt vmcnt(5)
    s_cmp_ge_u32 s16, 1
    s_cbranch_scc1 L_sn78
    s_waitcnt vmcnt(4)
L_sn78:
    buffer_load_dwordx4 v6, s[24:27], s61 offen offset:2048 nt lds
    s_waitcnt vmcnt(6)
    s_cmp_ge_u32 s16, 2
    s_cbranch_scc1 L_sn79
    s_waitcnt vmcnt(5)
    s_cmp_ge_u32 s16, 1
    s_cbranch_scc1 L_sn79
    s_waitcnt vmcnt(4)
L_sn79:
    buffer_load_dwordx4 v7, s[24:27], s61 offen offset:3072 nt lds
L_qwn:
    ds_read_b32 v29, v31 offset:0
    s_waitcnt lgkmcnt(0)
    v_cmp_gt_u32 vcc, 1, v29
    s_and_b64 exec, exec, vcc
    s_cbranch_scc0 L_qwn_done
    s_sleep 1
    s_add_u32 s63, s63, 1
    s_cmp_lt_u32 s63, 1048576
    s_cbranch_scc1 L_qwn
L_qwn_done:
    s_mov_b64 exec, -1
    ds_read_b32 v29, v31 offset:16
    ds_read_b128 v[32:35], v30 offset:0
    ds_read_b128 v[36:39], v30 offset:64
    ds_read_b128 v[40:43], v30 offset:128
    ds_read_b128 v[44:47], v30 offset:192
    s_waitcnt lgkmcnt(0)
    v_readfirstlane_b32 s60, v29
    v_mfma_f32_16x16x32_bf16 v[48:51], v[224:227], v[32:35], 0
    v_mfma_f32_16x16x32_bf16 v[48:51], v[228:231], v[36:39], v[48:51]
    v_mfma_f32_16x16x32_bf16 v[48:51], v[232:235], v[40:43], v[48:51]
    v_mfma_f32_16x16x32_bf16 v[48:51], v[236:239], v[44:47], v[48:51]
    v_mfma_f32_16x16x32_bf16 v[52:55], v[240:243], v[32:35], 0
    v_mfma_f32_16x16x32_bf16 v[52:55], v[244:247], v[36:39], v[52:55]
    v_mfma_f32_16x16x32_bf16 v[52:55], v[248:251], v[40:43], v[52:55]
    v_mfma_f32_16x16x32_bf16 v[52:55], v[252:255], v[44:47], v[52:55]
    ds_read_b32 v28, v31 offset:20
    ds_read_b128 v[224:227], v8 offset:0
    ds_read_b128 v[228:231], v9 offset:0
    ds_read_b128 v[232:235], v10 offset:0
    ds_read_b128 v[236:239], v11 offset:0
    ds_read_b128 v[240:243], v8 offset:4096
    ds_read_b128 v[244:247], v9 offset:4096
    ds_read_b128 v[248:251], v10 offset:4096
    ds_read_b128 v[252:255], v11 offset:4096
    v_mfma_f32_16x16x32_bf16 v[56:59], v[64:67], v[32:35], 0
    v_mfma_f32_16x16x32_bf16 v[56:59], v[68:71], v[36:39], v[56:59]
    v_mfma_f32_16x16x32_bf16 v[56:59], v[72:75], v[40:43], v[56:59]
    v_mfma_f32_16x16x32_bf16 v[56:59], v[76:79], v[44:47], v[56:59]
    v_mfma_f32_16x16x32_bf16 v[60:63], v[80:83], v[32:35], 0
    v_mfma_f32_16x16x32_bf16 v[60:63], v[84:87], v[36:39], v[60:63]
    v_mfma_f32_16x16x32_bf16 v[60:63], v[88:91], v[40:43], v[60:63]
    v_mfma_f32_16x16x32_bf16 v[60:63], v[92:95], v[44:47], v[60:63]
    s_waitcnt lgkmcnt(0)
    v_readfirstlane_b32 s16, v28
    s_add_u32 m0, s56, 0
    s_add_u32 s61, s55, 36864
    buffer_load_dwordx4 v6, s[24:27], s61 offen offset:0 nt lds
    v_mfma_f32_16x16x32_bf16 v[64:67], v[224:227], v[32:35], 0
    v_mfma_f32_16x16x32_bf16 v[64:67], v[228:231], v[36:39], v[64:67]
    v_mfma_f32_16x16x32_bf16 v[64:67], v[232:235], v[40:43], v[64:67]
    v_mfma_f32_16x16x32_bf16 v[64:67], v[236:239], v[44:47], v[64:67]
    v_mfma_f32_16x16x32_bf16 v[68:71], v[240:243], v[32:35], 0
    v_mfma_f32_16x16x32_bf16 v[68:71], v[244:247], v[36:39], v[68:71]
    v_mfma_f32_16x16x32_bf16 v[68:71], v[248:251], v[40:43], v[68:71]
    v_mfma_f32_16x16x32_bf16 v[68:71], v[252:255], v[44:47], v[68:71]
    ds_read_b32 v28, v31 offset:20
    ds_read_b128 v[224:227], v8 offset:8192
    ds_read_b128 v[228:231], v9 offset:8192
    ds_read_b128 v[232:235], v10 offset:8192
    ds_read_b128 v[236:239], v11 offset:8192
    ds_read_b128 v[240:243], v8 offset:12288
    ds_read_b128 v[244:247], v9 offset:12288
    ds_read_b128 v[248:251], v10 offset:12288
    ds_read_b128 v[252:255], v11 offset:12288
    v_mfma_f32_16x16x32_bf16 v[72:75], v[96:99], v[32:35], 0
    v_mfma_f32_16x16x32_bf16 v[72:75], v[100:103], v[36:39], v[72:75]
    v_mfma_f32_16x16x32_bf16 v[72:75], v[104:107], v[40:43], v[72:75]
    v_mfma_f32_16x16x32_bf16 v[72:75], v[108:111], v[44:47], v[72:75]
    v_mfma_f32_16x16x32_bf16 v[76:79], v[112:115], v[32:35], 0
    v_mfma_f32_16x16x32_bf16 v[76:79], v[116:119], v[36:39], v[76:79]
    v_mfma_f32_16x16x32_bf16 v[76:79], v[120:123], v[40:43], v[76:79]
    v_mfma_f32_16x16x32_bf16 v[76:79], v[124:127], v[44:47], v[76:79]
    s_waitcnt lgkmcnt(0)
    v_readfirstlane_b32 s16, v28
    buffer_load_dwordx4 v7, s[24:27], s61 offen offset:1024 nt lds
    v_mfma_f32_16x16x32_bf16 v[80:83], v[224:227], v[32:35], 0
    v_mfma_f32_16x16x32_bf16 v[80:83], v[228:231], v[36:39], v[80:83]
    v_mfma_f32_16x16x32_bf16 v[80:83], v[232:235], v[40:43], v[80:83]
    v_mfma_f32_16x16x32_bf16 v[80:83], v[236:239], v[44:47], v[80:83]
    v_mfma_f32_16x16x32_bf16 v[84:87], v[240:243], v[32:35], 0
    v_mfma_f32_16x16x32_bf16 v[84:87], v[244:247], v[36:39], v[84:87]
    v_mfma_f32_16x16x32_bf16 v[84:87], v[248:251], v[40:43], v[84:87]
    v_mfma_f32_16x16x32_bf16 v[84:87], v[252:255], v[44:47], v[84:87]
    ds_read_b32 v28, v31 offset:20
    ds_read_b128 v[224:227], v8 offset:16384
    ds_read_b128 v[228:231], v9 offset:16384
    ds_read_b128 v[232:235], v10 offset:16384
    ds_read_b128 v[236:239], v11 offset:16384
    v_mfma_f32_16x16x32_bf16 v[88:91], v[128:131], v[32:35], 0
    v_mfma_f32_16x16x32_bf16 v[88:91], v[132:135], v[36:39], v[88:91]
    v_mfma_f32_16x16x32_bf16 v[88:91], v[136:139], v[40:43], v[88:91]
    v_mfma_f32_16x16x32_bf16 v[88:91], v[140:143], v[44:47], v[88:91]
    v_mfma_f32_16x16x32_bf16 v[92:95], v[144:147], v[32:35], 0
    v_mfma_f32_16x16x32_bf16 v[92:95], v[148:151], v[36:39], v[92:95]
    v_mfma_f32_16x16x32_bf16 v[92:95], v[152:155], v[40:43], v[92:95]
    v_mfma_f32_16x16x32_bf16 v[92:95], v[156:159], v[44:47], v[92:95]
    s_waitcnt lgkmcnt(0)
    v_readfirstlane_b32 s16, v28
    buffer_load_dwordx4 v6, s[24:27], s61 offen offset:2048 nt lds
    v_mfma_f32_16x16x32_bf16 v[96:99], v[224:227], v[32:35], 0
    v_mfma_f32_16x16x32_bf16 v[96:99], v[228:231], v[36:39], v[96:99]
    v_mfma_f32_16x16x32_bf16 v[96:99], v[232:235], v[40:43], v[96:99]
    v_mfma_f32_16x16x32_bf16 v[96:99], v[236:239], v[44:47], v[96:99]
    v_mfma_f32_16x16x32_bf16 v[104:107], v[160:163], v[32:35], 0
    v_mfma_f32_16x16x32_bf16 v[104:107], v[164:167], v[36:39], v[104:107]
    v_mfma_f32_16x16x32_bf16 v[104:107], v[168:171], v[40:43], v[104:107]
    v_mfma_f32_16x16x32_bf16 v[104:107], v[172:175], v[44:47], v[104:107]
    v_mfma_f32_16x16x32_bf16 v[108:111], v[176:179], v[32:35], 0
    v_mfma_f32_16x16x32_bf16 v[108:111], v[180:183], v[36:39], v[108:111]
    v_mfma_f32_16x16x32_bf16 v[108:111], v[184:187], v[40:43], v[108:111]
    v_mfma_f32_16x16x32_bf16 v[108:111], v[188:191], v[44:47], v[108:111]
    buffer_load_dwordx4 v7, s[24:27], s61 offen offset:3072 nt lds
    v_mfma_f32_16x16x32_bf16 v[112:115], v[192:195], v[32:35], 0
    v_mfma_f32_16x16x32_bf16 v[112:115], v[196:199], v[36:39], v[112:115]
    v_mfma_f32_16x16x32_bf16 v[112:115], v[200:203], v[40:43], v[112:115]
    v_mfma_f32_16x16x32_bf16 v[112:115], v[204:207], v[44:47], v[112:115]
    v_mfma_f32_16x16x32_bf16 v[116:119], v[208:211], v[32:35], 0
    v_mfma_f32_16x16x32_bf16 v[116:119], v[212:215], v[36:39], v[116:119]
    v_mfma_f32_16x16x32_bf16 v[116:119], v[216:219], v[40:43], v[116:119]
    v_mfma_f32_16x16x32_bf16 v[116:119], v[220:223], v[44:47], v[116:119]
    s_nop 7
    v_max3_f32 v22, v56, v57, v58
    v_max3_f32 v23, v59, v60, v61
    v_max3_f32 v24, v62, v63, v72
    v_max3_f32 v25, v73, v74, v75
    v_max3_f32 v22, v22, v76, v77
    v_max3_f32 v23, v23, v78, v79
    v_max3_f32 v24, v24, v88, v89
    v_max3_f32 v25, v25, v90, v91
    v_max3_f32 v22, v22, v92, v93
    v_max3_f32 v23, v23, v94, v95
    v_max3_f32 v24, v24, v104, v105
    v_max3_f32 v25, v25, v106, v107
    v_max3_f32 v22, v22, v108, v109
    v_max3_f32 v23, v23, v110, v111
    v_max3_f32 v24, v24, v112, v113
    v_max3_f32 v25, v25, v114, v115
    v_max3_f32 v22, v22, v116, v117
    v_max3_f32 v23, v23, v118, v119
    v_max3_f32 v24, v24, v48, v49
    v_max3_f32 v25, v25, v50, v51
    v_max3_f32 v22, v22, v52, v53
    v_max3_f32 v23, v23, v54, v55
    v_max3_f32 v24, v24, v64, v65
    v_max3_f32 v25, v25, v66, v67
    v_max3_f32 v22, v22, v68, v69
    v_max3_f32 v23, v23, v70, v71
    v_max3_f32 v24, v24, v80, v81
    v_max3_f32 v25, v25, v82, v83
    v_max3_f32 v22, v22, v84, v85
    v_max3_f32 v23, v23, v86, v87
    v_max3_f32 v24, v24, v96, v97
    v_max3_f32 v25, v25, v98, v99
    v_max3_f32 v22, v22, v23, v24
    v_max_f32 v22, v22, v25
    v_mov_b32 v23, v22
    s_nop 1
    v_permlane32_swap_b32 v22, v23
    v_max_f32 v22, v22, v23
    v_mov_b32 v23, v22
    s_nop 1
    v_permlane16_swap_b32 v22, v23
    v_max_f32 v22, v22, v23
    v_mul_f32 v24, s62, v22
    s_mov_b32 vcc_lo, 0xff00ff00
    s_mov_b32 vcc_hi, 0xff00ff00
    s_add_u32 m0, s56, 4096
    s_add_u32 s61, s55, 65536
    buffer_load_dwordx4 v6, s[24:27], s61 offen offset:0 nt lds
    v_fma_f32 v56, v56, s62, -v24
    v_fma_f32 v57, v57, s62, -v24
    v_fma_f32 v58, v58, s62, -v24
    v_fma_f32 v59, v59, s62, -v24
    v_fma_f32 v60, v60, s62, -v24
    v_fma_f32 v61, v61, s62, -v24
    v_fma_f32 v62, v62, s62, -v24
    v_fma_f32 v63, v63, s62, -v24
    v_exp_f32 v56, v56
    v_exp_f32 v57, v57
    v_exp_f32 v58, v58
    v_exp_f32 v59, v59
    v_exp_f32 v60, v60
    v_exp_f32 v61, v61
    v_exp_f32 v62, v62
    v_exp_f32 v63, v63
    v_add_f32 v120, v56, v60
    v_add_f32 v121, v57, v61
    v_add_f32 v122, v58, v62
    v_add_f32 v123, v59, v63
    v_cvt_pk_bf16_f32 v56, v56, v57
    v_cvt_pk_bf16_f32 v57, v58, v59
    v_cvt_pk_bf16_f32 v58, v60, v61
    v_cvt_pk_bf16_f32 v59, v62, v63
    v_cndmask_b32 v60, 0, v56, vcc
    v_xor_b32 v56, v56, v60
    v_cndmask_b32 v61, 0, v57, vcc
    v_xor_b32 v57, v57, v61
    v_cndmask_b32 v62, 0, v58, vcc
    v_xor_b32 v58, v58, v62
    v_cndmask_b32 v63, 0, v59, vcc
    v_xor_b32 v59, v59, v63
    buffer_load_dwordx4 v7, s[24:27], s61 offen offset:1024 nt lds
    v_fma_f32 v72, v72, s62, -v24
    v_fma_f32 v73, v73, s62, -v24
    v_fma_f32 v74, v74, s62, -v24
    v_fma_f32 v75, v75, s62, -v24
    v_fma_f32 v76, v76, s62, -v24
    v_fma_f32 v77, v77, s62, -v24
    v_fma_f32 v78, v78, s62, -v24
    v_fma_f32 v79, v79, s62, -v24
    v_exp_f32 v72, v72
    v_exp_f32 v73, v73
    v_exp_f32 v74, v74
    v_exp_f32 v75, v75
    v_exp_f32 v76, v76
    v_exp_f32 v77, v77
    v_exp_f32 v78, v78
    v_exp_f32 v79, v79
    v_add_f32 v120, v120, v72
    v_add_f32 v121, v121, v73
    v_add_f32 v122, v122, v74
    v_add_f32 v123, v123, v75
    v_add_f32 v120, v120, v76
    v_add_f32 v121, v121, v77
    v_add_f32 v122, v122, v78
    v_add_f32 v123, v123, v79
    v_cvt_pk_bf16_f32 v72, v72, v73
    v_cvt_pk_bf16_f32 v73, v74, v75
    v_cvt_pk_bf16_f32 v74, v76, v77
    v_cvt_pk_bf16_f32 v75, v78, v79
    v_cndmask_b32 v76, 0, v72, vcc
    v_xor_b32 v72, v72, v76
    v_cndmask_b32 v77, 0, v73, vcc
    v_xor_b32 v73, v73, v77
    v_cndmask_b32 v78, 0, v74, vcc
    v_xor_b32 v74, v74, v78
    v_cndmask_b32 v79, 0, v75, vcc
    v_xor_b32 v75, v75, v79
    buffer_load_dwordx4 v6, s[24:27], s61 offen offset:2048 nt lds
    v_fma_f32 v88, v88, s62, -v24
    v_fma_f32 v89, v89, s62, -v24
    v_fma_f32 v90, v90, s62, -v24
    v_fma_f32 v91, v91, s62, -v24
    v_fma_f32 v92, v92, s62, -v24
    v_fma_f32 v93, v93, s62, -v24
    v_fma_f32 v94, v94, s62, -v24
    v_fma_f32 v95, v95, s62, -v24
    v_exp_f32 v88, v88
    v_exp_f32 v89, v89
    v_exp_f32 v90, v90
    v_exp_f32 v91, v91
    v_exp_f32 v92, v92
    v_exp_f32 v93, v93
    v_exp_f32 v94, v94
    v_exp_f32 v95, v95
    v_add_f32 v120, v120, v88
    v_add_f32 v121, v121, v89
    v_add_f32 v122, v122, v90
    v_add_f32 v123, v123, v91
    v_add_f32 v120, v120, v92
    v_add_f32 v121, v121, v93
    v_add_f32 v122, v122, v94
    v_add_f32 v123, v123, v95
    v_cvt_pk_bf16_f32 v88, v88, v89
    v_cvt_pk_bf16_f32 v89, v90, v91
    v_cvt_pk_bf16_f32 v90, v92, v93
    v_cvt_pk_bf16_f32 v91, v94, v95
    v_cndmask_b32 v92, 0, v88, vcc
    v_xor_b32 v88, v88, v92
    v_cndmask_b32 v93, 0, v89, vcc
    v_xor_b32 v89, v89, v93
    v_cndmask_b32 v94, 0, v90, vcc
    v_xor_b32 v90, v90, v94
    v_cndmask_b32 v95, 0, v91, vcc
    v_xor_b32 v91, v91, v95
    buffer_load_dwordx4 v7, s[24:27], s61 offen offset:3072 nt lds
    v_fma_f32 v104, v104, s62, -v24
    v_fma_f32 v105, v105, s62, -v24
    v_fma_f32 v106, v106, s62, -v24
    v_fma_f32 v107, v107, s62, -v24
    v_fma_f32 v108, v108, s62, -v24
    v_fma_f32 v109, v109, s62, -v24
    v_fma_f32 v110, v110, s62, -v24
    v_fma_f32 v111, v111, s62, -v24
    v_exp_f32 v104, v104
    v_exp_f32 v105, v105
    v_exp_f32 v106, v106
    v_exp_f32 v107, v107
    v_exp_f32 v108, v108
    v_exp_f32 v109, v109
    v_exp_f32 v110, v110
    v_exp_f32 v111, v111
    v_add_f32 v120, v120, v104
    v_add_f32 v121, v121, v105
    v_add_f32 v122, v122, v106
    v_add_f32 v123, v123, v107
    v_add_f32 v120, v120, v108
    v_add_f32 v121, v121, v109
    v_add_f32 v122, v122, v110
    v_add_f32 v123, v123, v111
    v_cvt_pk_bf16_f32 v104, v104, v105
    v_cvt_pk_bf16_f32 v105, v106, v107
    v_cvt_pk_bf16_f32 v106, v108, v109
    v_cvt_pk_bf16_f32 v107, v110, v111
    v_cndmask_b32 v108, 0, v104, vcc
    v_xor_b32 v104, v104, v108
    v_cndmask_b32 v109, 0, v105, vcc
    v_xor_b32 v105, v105, v109
    v_cndmask_b32 v110, 0, v106, vcc
    v_xor_b32 v106, v106, v110
    v_cndmask_b32 v111, 0, v107, vcc
    v_xor_b32 v107, v107, v111
    s_add_u32 m0, s56, 8192
    s_add_u32 s61, s55, 69632
    buffer_load_dwordx4 v6, s[24:27], s61 offen offset:0 nt lds
    v_fma_f32 v112, v112, s62, -v24
    v_fma_f32 v113, v113, s62, -v24
    v_fma_f32 v114, v114, s62, -v24
    v_fma_f32 v115, v115, s62, -v24
    v_fma_f32 v116, v116, s62, -v24
    v_fma_f32 v117, v117, s62, -v24
    v_fma_f32 v118, v118, s62, -v24
    v_fma_f32 v119, v119, s62, -v24
    v_exp_f32 v112, v112
    v_exp_f32 v113, v113
    v_exp_f32 v114, v114
    v_exp_f32 v115, v115
    v_exp_f32 v116, v116
    v_exp_f32 v117, v117
    v_exp_f32 v118, v118
    v_exp_f32 v119, v119
    v_add_f32 v120, v120, v112
    v_add_f32 v121, v121, v113
    v_add_f32 v122, v122, v114
    v_add_f32 v123, v123, v115
    v_add_f32 v120, v120, v116
    v_add_f32 v121, v121, v117
    v_add_f32 v122, v122, v118
    v_add_f32 v123, v123, v119
    v_cvt_pk_bf16_f32 v112, v112, v113
    v_cvt_pk_bf16_f32 v113, v114, v115
    v_cvt_pk_bf16_f32 v114, v116, v117
    v_cvt_pk_bf16_f32 v115, v118, v119
    v_cndmask_b32 v116, 0, v112, vcc
    v_xor_b32 v112, v112, v116
    v_cndmask_b32 v117, 0, v113, vcc
    v_xor_b32 v113, v113, v117
    v_cndmask_b32 v118, 0, v114, vcc
    v_xor_b32 v114, v114, v118
    v_cndmask_b32 v119, 0, v115, vcc
    v_xor_b32 v115, v115, v119
    buffer_load_dwordx4 v7, s[24:27], s61 offen offset:1024 nt lds
    v_fma_f32 v48, v48, s62, -v24
    v_fma_f32 v49, v49, s62, -v24
    v_fma_f32 v50, v50, s62, -v24
    v_fma_f32 v51, v51, s62, -v24
    v_fma_f32 v52, v52, s62, -v24
    v_fma_f32 v53, v53, s62, -v24
    v_fma_f32 v54, v54, s62, -v24
    v_fma_f32 v55, v55, s62, -v24
    v_exp_f32 v48, v48
    v_exp_f32 v49, v49
    v_exp_f32 v50, v50
    v_exp_f32 v51, v51
    v_exp_f32 v52, v52
    v_exp_f32 v53, v53
    v_exp_f32 v54, v54
    v_exp_f32 v55, v55
    v_add_f32 v120, v120, v48
    v_add_f32 v121, v121, v49
    v_add_f32 v122, v122, v50
    v_add_f32 v123, v123, v51
    v_add_f32 v120, v120, v52
    v_add_f32 v121, v121, v53
    v_add_f32 v122, v122, v54
    v_add_f32 v123, v123, v55
    v_cvt_pk_bf16_f32 v48, v48, v49
    v_cvt_pk_bf16_f32 v49, v50, v51
    v_cvt_pk_bf16_f32 v50, v52, v53
    v_cvt_pk_bf16_f32 v51, v54, v55
    v_cndmask_b32 v52, 0, v48, vcc
    v_xor_b32 v48, v48, v52
    v_cndmask_b32 v53, 0, v49, vcc
    v_xor_b32 v49, v49, v53
    v_cndmask_b32 v54, 0, v50, vcc
    v_xor_b32 v50, v50, v54
    v_cndmask_b32 v55, 0, v51, vcc
    v_xor_b32 v51, v51, v55
    buffer_load_dwordx4 v6, s[24:27], s61 offen offset:2048 nt lds
    v_fma_f32 v64, v64, s62, -v24
    v_fma_f32 v65, v65, s62, -v24
    v_fma_f32 v66, v66, s62, -v24
    v_fma_f32 v67, v67, s62, -v24
    v_fma_f32 v68, v68, s62, -v24
    v_fma_f32 v69, v69, s62, -v24
    v_fma_f32 v70, v70, s62, -v24
    v_fma_f32 v71, v71, s62, -v24
    v_exp_f32 v64, v64
    v_exp_f32 v65, v65
    v_exp_f32 v66, v66
    v_exp_f32 v67, v67
    v_exp_f32 v68, v68
    v_exp_f32 v69, v69
    v_exp_f32 v70, v70
    v_exp_f32 v71, v71
    v_add_f32 v120, v120, v64
    v_add_f32 v121, v121, v65
    v_add_f32 v122, v122, v66
    v_add_f32 v123, v123, v67
    v_add_f32 v120, v120, v68
    v_add_f32 v121, v121, v69
    v_add_f32 v122, v122, v70
    v_add_f32 v123, v123, v71
    v_cvt_pk_bf16_f32 v64, v64, v65
    v_cvt_pk_bf16_f32 v65, v66, v67
    v_cvt_pk_bf16_f32 v66, v68, v69
    v_cvt_pk_bf16_f32 v67, v70, v71
    v_cndmask_b32 v68, 0, v64, vcc
    v_xor_b32 v64, v64, v68
    v_cndmask_b32 v69, 0, v65, vcc
    v_xor_b32 v65, v65, v69
    v_cndmask_b32 v70, 0, v66, vcc
    v_xor_b32 v66, v66, v70
    v_cndmask_b32 v71, 0, v67, vcc
    v_xor_b32 v67, v67, v71
    buffer_load_dwordx4 v7, s[24:27], s61 offen offset:3072 nt lds
    v_fma_f32 v80, v80, s62, -v24
    v_fma_f32 v81, v81, s62, -v24
    v_fma_f32 v82, v82, s62, -v24
    v_fma_f32 v83, v83, s62, -v24
    v_fma_f32 v84, v84, s62, -v24
    v_fma_f32 v85, v85, s62, -v24
    v_fma_f32 v86, v86, s62, -v24
    v_fma_f32 v87, v87, s62, -v24
    v_exp_f32 v80, v80
    v_exp_f32 v81, v81
    v_exp_f32 v82, v82
    v_exp_f32 v83, v83
    v_exp_f32 v84, v84
    v_exp_f32 v85, v85
    v_exp_f32 v86, v86
    v_exp_f32 v87, v87
    v_add_f32 v120, v120, v80
    v_add_f32 v121, v121, v81
    v_add_f32 v122, v122, v82
    v_add_f32 v123, v123, v83
    v_add_f32 v120, v120, v84
    v_add_f32 v121, v121, v85
    v_add_f32 v122, v122, v86
    v_add_f32 v123, v123, v87
    v_cvt_pk_bf16_f32 v80, v80, v81
    v_cvt_pk_bf16_f32 v81, v82, v83
    v_cvt_pk_bf16_f32 v82, v84, v85
    v_cvt_pk_bf16_f32 v83, v86, v87
    v_cndmask_b32 v84, 0, v80, vcc
    v_xor_b32 v80, v80, v84
    v_cndmask_b32 v85, 0, v81, vcc
    v_xor_b32 v81, v81, v85
    v_cndmask_b32 v86, 0, v82, vcc
    v_xor_b32 v82, v82, v86
    v_cndmask_b32 v87, 0, v83, vcc
    v_xor_b32 v83, v83, v87
    s_add_u32 m0, s56, 12288
    s_add_u32 s61, s55, 98304
    buffer_load_dwordx4 v6, s[24:27], s61 offen offset:0 nt lds
    v_fma_f32 v96, v96, s62, -v24
    v_fma_f32 v97, v97, s62, -v24
    v_fma_f32 v98, v98, s62, -v24
    v_fma_f32 v99, v99, s62, -v24
    v_exp_f32 v96, v96
    v_exp_f32 v97, v97
    v_exp_f32 v98, v98
    v_exp_f32 v99, v99
    v_add_f32 v120, v120, v96
    v_add_f32 v121, v121, v97
    v_add_f32 v122, v122, v98
    v_add_f32 v123, v123, v99
    v_cvt_pk_bf16_f32 v96, v96, v97
    v_cvt_pk_bf16_f32 v97, v98, v99
    v_cndmask_b32 v98, 0, v96, vcc
    v_xor_b32 v96, v96, v98
    v_cndmask_b32 v99, 0, v97, vcc
    v_xor_b32 v97, v97, v99
    v_add_f32 v120, v120, v121
    v_add_f32 v122, v122, v123
    v_add_f32 v23, v120, v122
    v_mov_b32 v24, v23
    s_nop 1
    v_permlane32_swap_b32 v23, v24
    v_add_f32 v23, v23, v24
    v_mov_b32 v24, v23
    s_nop 1
    v_permlane16_swap_b32 v23, v24
    v_add_f32 v23, v23, v24
    s_lshl_b32 s57, s52, 6
    s_add_u32 s57, s57, 154240
    v_lshl_add_u32 v24, v1, 3, s57
    s_mov_b64 exec, 0xff
    ds_write_b64 v24, v[22:23]
    s_mov_b64 exec, -1
    v_mov_b32 v29, 1
    s_mov_b64 exec, 1
    ds_add_u32 v31, v29 offset:12
    s_mov_b64 exec, -1
    s_waitcnt lgkmcnt(0)
    v_lshrrev_b32 v25, 4, v1
    v_and_b32 v26, 15, v1
    v_subrev_u32 v208, s56, v8
    v_add_u32 v208, 150016, v208
    v_subrev_u32 v209, s56, v9
    v_add_u32 v209, 150016, v209
    v_subrev_u32 v210, s56, v10
    v_add_u32 v210, 150016, v210
    v_subrev_u32 v211, s56, v11
    v_add_u32 v211, 150016, v211
    v_add_u32 v217, 0x10000, v21
    v_and_b32 v27, 7, v1
    v_mul_u32_u24 v27, 528, v27
    v_lshl_add_u32 v27, v25, 4, v27
    v_and_b32 v28, 8, v1
    v_lshl_add_u32 v27, v28, 5, v27
    s_mul_i32 s57, s52, 4224
    s_add_u32 s57, s57, 131072
    v_add_u32 v212, s57, v27
    v_lshrrev_b32 v24, 5, v1
    s_lshl_b32 s57, s52, 1
    v_add_u32 v27, s57, v24
    v_and_b32 v28, 31, v1
    v_mul_u32_u24 v29, 528, v27
    v_lshl_add_u32 v29, v28, 4, v29
    v_add_u32 v213, 131072, v29
    v_lshlrev_b32 v29, 4, v27
    v_add_u32 v214, 154112, v29
    v_lshlrev_b32 v29, 3, v28
    v_lshl_or_b32 v215, v27, 14, v29
    s_and_b32 s57, s64, 3
    s_lshl_b32 s57, s57, 17
    s_lshl_b32 s59, s65, 12
    s_add_u32 s57, s57, s59
    s_lshr_b32 s59, s64, 2
    s_lshl_b32 s59, s59, 8
    s_add_u32 s57, s57, s59
    v_add_u32 v215, s57, v215
    s_lshl_b32 s57, s52, 2
    v_add_u32 v27, s57, v25
    v_xor_b32 v28, v26, v27
    v_lshlrev_b32 v28, 4, v28
    v_lshl_or_b32 v28, v27, 8, v28
    v_add_u32 v192, 150016, v28
    v_lshrrev_b32 v28, 3, v1
    v_and_b32 v29, 7, v1
    v_lshlrev_b32 v29, 4, v29
    v_lshl_or_b32 v218, v28, 12, v29
    s_lshl_b32 s57, s53, 17
    s_lshl_b32 s59, s52, 15
    s_add_u32 s57, s57, s59
    s_lshl_b32 s59, s54, 7
    s_add_u32 s57, s57, s59
    s_add_u32 s57, s57, 1048576
    v_add_u32 v218, s57, v218
    s_lshl_b32 s57, s53, 5
    s_add_u32 s57, s57, s54
    s_lshl_b32 s98, s57, 12
    s_add_u32 s98, s98, 1048576
    s_lshl_b32 s59, s52, 5
    s_add_u32 s70, s98, s59
    s_lshl_b32 s59, s52, 10
    s_add_u32 s98, s98, s59
    v_lshrrev_b32 v28, 1, v1
    v_and_b32 v29, 1, v1
    v_lshlrev_b32 v27, 4, v29
    v_lshl_or_b32 v219, v28, 7, v27
    v_lshlrev_b32 v220, 11, v29
    v_lshl_add_u32 v220, v25, 2, v220
    s_lshl_b32 s59, s52, 12
    v_add_u32 v220, s59, v220
    s_and_b32 s59, s57, 1
    s_lshl_b32 s59, s59, 14
    s_lshr_b32 s57, s57, 1
    s_lshl_b32 s57, s57, 4
    s_add_u32 s57, s57, s59
    v_add_u32 v220, s57, v220
    v_lshlrev_b32 v216, 4, v1
    s_lshl_b32 s66, s54, 14
    s_lshl_b32 s59, s52, 10
    s_add_u32 s66, s66, s59
    s_add_u32 s67, s66, 4096
    s_add_u32 s68, s66, 8192
    s_add_u32 s69, s66, 12288
    v_lshlrev_b32 v222, 7, v1
    v_mov_b32 v194, 0x397001e0
    v_mov_b32 v195, 0x00070007
    v_mov_b32 v196, 0x38e001c0
    s_bfe_u32 s99, s60, 0x80000
    s_mul_i32 s99, s99, 0x2001
    s_and_b32 s99, s99, 0x00070007
    s_bfe_u32 s100, s60, 0x80008
    s_mul_i32 s100, s100, 0x2001
    s_and_b32 s100, s100, 0x00070007
    s_bfe_u32 s101, s60, 0x80010
    s_mul_i32 s101, s101, 0x2001
    s_and_b32 s101, s101, 0x00070007
    s_mov_b32 s3, 0x000f000f
    v_and_b32 v27, 1, v1
    v_cmp_eq_u32 vcc, 1, v27
    v_mov_b32 v27, s3
    v_mov_b32 v28, 0x1001
    v_cndmask_b32 v198, v194, v196, vcc
    v_cndmask_b32 v200, v27, v195, vcc
    v_cndmask_b32 v201, v28, 0, vcc
    v_mov_b32 v27, s100
    v_cndmask_b32 v202, 0, v27, vcc
    v_mov_b32 v27, s99
    v_mov_b32 v28, s101
    v_cndmask_b32 v203, v27, v28, vcc
    s_waitcnt vmcnt(6)
    s_cmp_ge_u32 s16, 2
    s_cbranch_scc1 L_sn93
    s_waitcnt vmcnt(5)
    s_cmp_ge_u32 s16, 1
    s_cbranch_scc1 L_sn93
    s_waitcnt vmcnt(4)
L_sn93:
    buffer_load_dwordx4 v7, s[24:27], s61 offen offset:1024 nt lds
    ds_read_b32 v28, v31 offset:20
    ds_read_b64_tr_b16 v[224:225], v12 offset:20480
    ds_read_b64_tr_b16 v[226:227], v12 offset:24576
    ds_read_b64_tr_b16 v[240:241], v16 offset:20480
    ds_read_b64_tr_b16 v[242:243], v16 offset:24576
    ds_read_b64_tr_b16 v[228:229], v13 offset:20480
    ds_read_b64_tr_b16 v[230:231], v13 offset:24576
    ds_read_b64_tr_b16 v[244:245], v17 offset:20480
    ds_read_b64_tr_b16 v[246:247], v17 offset:24576
    ds_read_b64_tr_b16 v[232:233], v14 offset:20480
    ds_read_b64_tr_b16 v[234:235], v14 offset:24576
    ds_read_b64_tr_b16 v[248:249], v18 offset:20480
    ds_read_b64_tr_b16 v[250:251], v18 offset:24576
    ds_read_b64_tr_b16 v[236:237], v15 offset:20480
    ds_read_b64_tr_b16 v[238:239], v15 offset:24576
    ds_read_b64_tr_b16 v[252:253], v19 offset:20480
    ds_read_b64_tr_b16 v[254:255], v19 offset:24576
    s_waitcnt lgkmcnt(14)
    v_mfma_f32_16x16x32_bf16 v[128:131], v[224:227], v[56:59], 0
    s_waitcnt lgkmcnt(12)
    v_mfma_f32_16x16x32_bf16 v[128:131], v[240:243], v[60:63], v[128:131]
    s_waitcnt lgkmcnt(10)
    v_mfma_f32_16x16x32_bf16 v[132:135], v[228:231], v[56:59], 0
    s_waitcnt lgkmcnt(8)
    v_mfma_f32_16x16x32_bf16 v[132:135], v[244:247], v[60:63], v[132:135]
    s_waitcnt lgkmcnt(6)
    v_mfma_f32_16x16x32_bf16 v[136:139], v[232:235], v[56:59], 0
    s_waitcnt lgkmcnt(4)
    v_mfma_f32_16x16x32_bf16 v[136:139], v[248:251], v[60:63], v[136:139]
    s_waitcnt lgkmcnt(2)
    v_mfma_f32_16x16x32_bf16 v[140:143], v[236:239], v[56:59], 0
    s_waitcnt lgkmcnt(0)
    v_mfma_f32_16x16x32_bf16 v[140:143], v[252:255], v[60:63], v[140:143]
    v_readfirstlane_b32 s16, v28
    ds_read_b32 v28, v31 offset:20
    ds_read_b64_tr_b16 v[224:225], v12 offset:28672
    ds_read_b64_tr_b16 v[226:227], v12 offset:0
    ds_read_b64_tr_b16 v[240:241], v16 offset:28672
    ds_read_b64_tr_b16 v[242:243], v16 offset:0
    ds_read_b64_tr_b16 v[228:229], v13 offset:28672
    ds_read_b64_tr_b16 v[230:231], v13 offset:0
    ds_read_b64_tr_b16 v[244:245], v17 offset:28672
    ds_read_b64_tr_b16 v[246:247], v17 offset:0
    ds_read_b64_tr_b16 v[232:233], v14 offset:28672
    ds_read_b64_tr_b16 v[234:235], v14 offset:0
    ds_read_b64_tr_b16 v[248:249], v18 offset:28672
    ds_read_b64_tr_b16 v[250:251], v18 offset:0
    ds_read_b64_tr_b16 v[236:237], v15 offset:28672
    ds_read_b64_tr_b16 v[238:239], v15 offset:0
    ds_read_b64_tr_b16 v[252:253], v19 offset:28672
    ds_read_b64_tr_b16 v[254:255], v19 offset:0
    s_waitcnt lgkmcnt(14)
    v_mfma_f32_16x16x32_bf16 v[128:131], v[224:227], v[72:75], v[128:131]
    s_waitcnt lgkmcnt(12)
    v_mfma_f32_16x16x32_bf16 v[128:131], v[240:243], v[76:79], v[128:131]
    s_waitcnt lgkmcnt(10)
    v_mfma_f32_16x16x32_bf16 v[132:135], v[228:231], v[72:75], v[132:135]
    s_waitcnt lgkmcnt(8)
    v_mfma_f32_16x16x32_bf16 v[132:135], v[244:247], v[76:79], v[132:135]
    s_waitcnt lgkmcnt(6)
    v_mfma_f32_16x16x32_bf16 v[136:139], v[232:235], v[72:75], v[136:139]
    s_waitcnt lgkmcnt(4)
    v_mfma_f32_16x16x32_bf16 v[136:139], v[248:251], v[76:79], v[136:139]
    s_waitcnt lgkmcnt(2)
    v_mfma_f32_16x16x32_bf16 v[140:143], v[236:239], v[72:75], v[140:143]
    s_waitcnt lgkmcnt(0)
    v_mfma_f32_16x16x32_bf16 v[140:143], v[252:255], v[76:79], v[140:143]
    v_readfirstlane_b32 s16, v28
    s_waitcnt vmcnt(6)
    s_cmp_ge_u32 s16, 2
    s_cbranch_scc1 L_sn94
    s_waitcnt vmcnt(5)
    s_cmp_ge_u32 s16, 1
    s_cbranch_scc1 L_sn94
    s_waitcnt vmcnt(4)
L_sn94:
    buffer_load_dwordx4 v6, s[24:27], s61 offen offset:2048 nt lds
    s_waitcnt vmcnt(6)
    s_cmp_ge_u32 s16, 2
    s_cbranch_scc1 L_sn95
    s_waitcnt vmcnt(5)
    s_cmp_ge_u32 s16, 1
    s_cbranch_scc1 L_sn95
    s_waitcnt vmcnt(4)
L_sn95:
    buffer_load_dwordx4 v7, s[24:27], s61 offen offset:3072 nt lds
    s_waitcnt vmcnt(6)
    s_cmp_ge_u32 s16, 2
    s_cbranch_scc1 L_sn96
    s_waitcnt vmcnt(5)
    s_cmp_ge_u32 s16, 1
    s_cbranch_scc1 L_sn96
    s_waitcnt vmcnt(4)
L_sn96:
    s_add_u32 m0, s56, 0
    s_add_u32 s61, s55, 102400
    buffer_load_dwordx4 v6, s[24:27], s61 offen offset:0 nt lds
    s_waitcnt vmcnt(6)
    s_cmp_ge_u32 s16, 2
    s_cbranch_scc1 L_sn97
    s_waitcnt vmcnt(5)
    s_cmp_ge_u32 s16, 1
    s_cbranch_scc1 L_sn97
    s_waitcnt vmcnt(4)
L_sn97:
    buffer_load_dwordx4 v7, s[24:27], s61 offen offset:1024 nt lds
    s_waitcnt vmcnt(6)
    s_cmp_ge_u32 s16, 2
    s_cbranch_scc1 L_sn98
    s_waitcnt vmcnt(5)
    s_cmp_ge_u32 s16, 1
    s_cbranch_scc1 L_sn98
    s_waitcnt vmcnt(4)
L_sn98:
    buffer_load_dwordx4 v6, s[24:27], s61 offen offset:2048 nt lds
    ds_read_b32 v28, v31 offset:20
    ds_read_b64_tr_b16 v[224:225], v12 offset:4096
    ds_read_b64_tr_b16 v[226:227], v12 offset:8192
    ds_read_b64_tr_b16 v[240:241], v16 offset:4096
    ds_read_b64_tr_b16 v[242:243], v16 offset:8192
    ds_read_b64_tr_b16 v[228:229], v13 offset:4096
    ds_read_b64_tr_b16 v[230:231], v13 offset:8192
    ds_read_b64_tr_b16 v[244:245], v17 offset:4096
    ds_read_b64_tr_b16 v[246:247], v17 offset:8192
    ds_read_b64_tr_b16 v[232:233], v14 offset:4096
    ds_read_b64_tr_b16 v[234:235], v14 offset:8192
    ds_read_b64_tr_b16 v[248:249], v18 offset:4096
    ds_read_b64_tr_b16 v[250:251], v18 offset:8192
    ds_read_b64_tr_b16 v[236:237], v15 offset:4096
    ds_read_b64_tr_b16 v[238:239], v15 offset:8192
    ds_read_b64_tr_b16 v[252:253], v19 offset:4096
    ds_read_b64_tr_b16 v[254:255], v19 offset:8192
    s_waitcnt lgkmcnt(14)
    v_mfma_f32_16x16x32_bf16 v[128:131], v[224:227], v[88:91], v[128:131]
    s_waitcnt lgkmcnt(12)
    v_mfma_f32_16x16x32_bf16 v[128:131], v[240:243], v[92:95], v[128:131]
    s_waitcnt lgkmcnt(10)
    v_mfma_f32_16x16x32_bf16 v[132:135], v[228:231], v[88:91], v[132:135]
    s_waitcnt lgkmcnt(8)
    v_mfma_f32_16x16x32_bf16 v[132:135], v[244:247], v[92:95], v[132:135]
    s_waitcnt lgkmcnt(6)
    v_mfma_f32_16x16x32_bf16 v[136:139], v[232:235], v[88:91], v[136:139]
    s_waitcnt lgkmcnt(4)
    v_mfma_f32_16x16x32_bf16 v[136:139], v[248:251], v[92:95], v[136:139]
    s_waitcnt lgkmcnt(2)
    v_mfma_f32_16x16x32_bf16 v[140:143], v[236:239], v[88:91], v[140:143]
    s_waitcnt lgkmcnt(0)
    v_mfma_f32_16x16x32_bf16 v[140:143], v[252:255], v[92:95], v[140:143]
    v_readfirstlane_b32 s16, v28
    s_waitcnt vmcnt(6)
    s_cmp_ge_u32 s16, 2
    s_cbranch_scc1 L_sn99
    s_waitcnt vmcnt(5)
    s_cmp_ge_u32 s16, 1
    s_cbranch_scc1 L_sn99
    s_waitcnt vmcnt(4)
L_sn99:
    buffer_load_dwordx4 v7, s[24:27], s61 offen offset:3072 nt lds
    v_mov_b32 v29, 1
    s_mov_b64 exec, 1
    ds_add_u32 v31, v29 offset:8
    s_mov_b64 exec, -1
    s_waitcnt vmcnt(6)
    s_cmp_ge_u32 s16, 2
    s_cbranch_scc1 L_sn100
    s_waitcnt vmcnt(5)
    s_cmp_ge_u32 s16, 1
    s_cbranch_scc1 L_sn100
    s_waitcnt vmcnt(4)
L_sn100:
    s_add_u32 m0, s56, 4096
    s_add_u32 s61, s55, 131072
    buffer_load_dwordx4 v6, s[24:27], s61 offen offset:0 nt lds
    s_waitcnt vmcnt(6)
    s_cmp_ge_u32 s16, 2
    s_cbranch_scc1 L_sn101
    s_waitcnt vmcnt(5)
    s_cmp_ge_u32 s16, 1
    s_cbranch_scc1 L_sn101
    s_waitcnt vmcnt(4)
L_sn101:
    buffer_load_dwordx4 v7, s[24:27], s61 offen offset:1024 nt lds
    s_waitcnt vmcnt(6)
    s_cmp_ge_u32 s16, 2
    s_cbranch_scc1 L_sn102
    s_waitcnt vmcnt(5)
    s_cmp_ge_u32 s16, 1
    s_cbranch_scc1 L_sn102
    s_waitcnt vmcnt(4)
L_sn102:
    buffer_load_dwordx4 v6, s[24:27], s61 offen offset:2048 nt lds
    s_waitcnt vmcnt(6)
    s_cmp_ge_u32 s16, 2
    s_cbranch_scc1 L_sn103
    s_waitcnt vmcnt(5)
    s_cmp_ge_u32 s16, 1
    s_cbranch_scc1 L_sn103
    s_waitcnt vmcnt(4)
L_sn103:
    buffer_load_dwordx4 v7, s[24:27], s61 offen offset:3072 nt lds
    s_waitcnt vmcnt(6)
    s_cmp_ge_u32 s16, 2
    s_cbranch_scc1 L_sn104
    s_waitcnt vmcnt(5)
    s_cmp_ge_u32 s16, 1
    s_cbranch_scc1 L_sn104
    s_waitcnt vmcnt(4)
L_sn104:
    s_add_u32 m0, s56, 8192
    s_add_u32 s61, s55, 135168
    buffer_load_dwordx4 v6, s[24:27], s61 offen offset:0 nt lds
    s_waitcnt vmcnt(6)
    s_cmp_ge_u32 s16, 2
    s_cbranch_scc1 L_sn105
    s_waitcnt vmcnt(5)
    s_cmp_ge_u32 s16, 1
    s_cbranch_scc1 L_sn105
    s_waitcnt vmcnt(4)
L_sn105:
    buffer_load_dwordx4 v7, s[24:27], s61 offen offset:1024 nt lds
    s_waitcnt vmcnt(6)
    s_cmp_ge_u32 s16, 2
    s_cbranch_scc1 L_sn106
    s_waitcnt vmcnt(5)
    s_cmp_ge_u32 s16, 1
    s_cbranch_scc1 L_sn106
    s_waitcnt vmcnt(4)
L_sn106:
    buffer_load_dwordx4 v6, s[24:27], s61 offen offset:2048 nt lds
    ds_read_b32 v28, v31 offset:20
    ds_read_b64_tr_b16 v[224:225], v12 offset:12288
    ds_read_b64_tr_b16 v[226:227], v12 offset:0
    ds_read_b64_tr_b16 v[240:241], v16 offset:12288
    ds_read_b64_tr_b16 v[242:243], v16 offset:0
    ds_read_b64_tr_b16 v[228:229], v13 offset:12288
    ds_read_b64_tr_b16 v[230:231], v13 offset:0
    ds_read_b64_tr_b16 v[244:245], v17 offset:12288
    ds_read_b64_tr_b16 v[246:247], v17 offset:0
    ds_read_b64_tr_b16 v[232:233], v14 offset:12288
    ds_read_b64_tr_b16 v[234:235], v14 offset:0
    ds_read_b64_tr_b16 v[248:249], v18 offset:12288
    ds_read_b64_tr_b16 v[250:251], v18 offset:0
    ds_read_b64_tr_b16 v[236:237], v15 offset:12288
    ds_read_b64_tr_b16 v[238:239], v15 offset:0
    ds_read_b64_tr_b16 v[252:253], v19 offset:12288
    ds_read_b64_tr_b16 v[254:255], v19 offset:0
    s_waitcnt lgkmcnt(14)
    v_mfma_f32_16x16x32_bf16 v[128:131], v[224:227], v[104:107], v[128:131]
    s_waitcnt lgkmcnt(12)
    v_mfma_f32_16x16x32_bf16 v[128:131], v[240:243], v[108:111], v[128:131]
    s_waitcnt lgkmcnt(10)
    v_mfma_f32_16x16x32_bf16 v[132:135], v[228:231], v[104:107], v[132:135]
    s_waitcnt lgkmcnt(8)
    v_mfma_f32_16x16x32_bf16 v[132:135], v[244:247], v[108:111], v[132:135]
    s_waitcnt lgkmcnt(6)
    v_mfma_f32_16x16x32_bf16 v[136:139], v[232:235], v[104:107], v[136:139]
    s_waitcnt lgkmcnt(4)
    v_mfma_f32_16x16x32_bf16 v[136:139], v[248:251], v[108:111], v[136:139]
    s_waitcnt lgkmcnt(2)
    v_mfma_f32_16x16x32_bf16 v[140:143], v[236:239], v[104:107], v[140:143]
    s_waitcnt lgkmcnt(0)
    v_mfma_f32_16x16x32_bf16 v[140:143], v[252:255], v[108:111], v[140:143]
    v_readfirstlane_b32 s16, v28
    s_waitcnt vmcnt(6)
    s_cmp_ge_u32 s16, 2
    s_cbranch_scc1 L_sn107
    s_waitcnt vmcnt(5)
    s_cmp_ge_u32 s16, 1
    s_cbranch_scc1 L_sn107
    s_waitcnt vmcnt(4)
L_sn107:
    buffer_load_dwordx4 v7, s[24:27], s61 offen offset:3072 nt lds
    s_waitcnt vmcnt(6)
    s_cmp_ge_u32 s16, 2
    s_cbranch_scc1 L_sn108
    s_waitcnt vmcnt(5)
    s_cmp_ge_u32 s16, 1
    s_cbranch_scc1 L_sn108
    s_waitcnt vmcnt(4)
L_sn108:
    s_add_u32 m0, s56, 0
    s_add_u32 s61, s55, 163840
    buffer_load_dwordx4 v6, s[24:27], s61 offen offset:0 nt lds
    s_waitcnt vmcnt(6)
    s_cmp_ge_u32 s16, 2
    s_cbranch_scc1 L_sn109
    s_waitcnt vmcnt(5)
    s_cmp_ge_u32 s16, 1
    s_cbranch_scc1 L_sn109
    s_waitcnt vmcnt(4)
L_sn109:
    buffer_load_dwordx4 v7, s[24:27], s61 offen offset:1024 nt lds
    s_waitcnt vmcnt(6)
    s_cmp_ge_u32 s16, 2
    s_cbranch_scc1 L_sn110
    s_waitcnt vmcnt(5)
    s_cmp_ge_u32 s16, 1
    s_cbranch_scc1 L_sn110
    s_waitcnt vmcnt(4)
L_sn110:
    buffer_load_dwordx4 v6, s[24:27], s61 offen offset:2048 nt lds
    s_waitcnt vmcnt(6)
    s_cmp_ge_u32 s16, 2
    s_cbranch_scc1 L_sn111
    s_waitcnt vmcnt(5)
    s_cmp_ge_u32 s16, 1
    s_cbranch_scc1 L_sn111
    s_waitcnt vmcnt(4)
L_sn111:
    buffer_load_dwordx4 v7, s[24:27], s61 offen offset:3072 nt lds
    s_waitcnt vmcnt(6)
    s_cmp_ge_u32 s16, 2
    s_cbranch_scc1 L_sn112
    s_waitcnt vmcnt(5)
    s_cmp_ge_u32 s16, 1
    s_cbranch_scc1 L_sn112
    s_waitcnt vmcnt(4)
L_sn112:
    s_add_u32 m0, s56, 12288
    s_add_u32 s61, s55, 167936
    buffer_load_dwordx4 v6, s[24:27], s61 offen offset:0 nt lds
    s_waitcnt vmcnt(6)
    s_cmp_ge_u32 s16, 2
    s_cbranch_scc1 L_sn113
    s_waitcnt vmcnt(5)
    s_cmp_ge_u32 s16, 1
    s_cbranch_scc1 L_sn113
    s_waitcnt vmcnt(4)
L_sn113:
    buffer_load_dwordx4 v7, s[24:27], s61 offen offset:1024 nt lds
    s_waitcnt vmcnt(6)
    s_cmp_ge_u32 s16, 2
    s_cbranch_scc1 L_sn114
    s_waitcnt vmcnt(5)
    s_cmp_ge_u32 s16, 1
    s_cbranch_scc1 L_sn114
    s_waitcnt vmcnt(4)
L_sn114:
    buffer_load_dwordx4 v6, s[24:27], s61 offen offset:2048 nt lds
    ds_read_b32 v28, v31 offset:20
    ds_read_b64_tr_b16 v[224:225], v12 offset:4096
    ds_read_b64_tr_b16 v[226:227], v12 offset:8192
    ds_read_b64_tr_b16 v[240:241], v16 offset:4096
    ds_read_b64_tr_b16 v[242:243], v16 offset:8192
    ds_read_b64_tr_b16 v[228:229], v13 offset:4096
    ds_read_b64_tr_b16 v[230:231], v13 offset:8192
    ds_read_b64_tr_b16 v[244:245], v17 offset:4096
    ds_read_b64_tr_b16 v[246:247], v17 offset:8192
    ds_read_b64_tr_b16 v[232:233], v14 offset:4096
    ds_read_b64_tr_b16 v[234:235], v14 offset:8192
    ds_read_b64_tr_b16 v[248:249], v18 offset:4096
    ds_read_b64_tr_b16 v[250:251], v18 offset:8192
    ds_read_b64_tr_b16 v[236:237], v15 offset:4096
    ds_read_b64_tr_b16 v[238:239], v15 offset:8192
    ds_read_b64_tr_b16 v[252:253], v19 offset:4096
    ds_read_b64_tr_b16 v[254:255], v19 offset:8192
    s_waitcnt lgkmcnt(14)
    v_mfma_f32_16x16x32_bf16 v[128:131], v[224:227], v[112:115], v[128:131]
    s_waitcnt lgkmcnt(12)
    v_mfma_f32_16x16x32_bf16 v[128:131], v[240:243], v[116:119], v[128:131]
    s_waitcnt lgkmcnt(10)
    v_mfma_f32_16x16x32_bf16 v[132:135], v[228:231], v[112:115], v[132:135]
    s_waitcnt lgkmcnt(8)
    v_mfma_f32_16x16x32_bf16 v[132:135], v[244:247], v[116:119], v[132:135]
    s_waitcnt lgkmcnt(6)
    v_mfma_f32_16x16x32_bf16 v[136:139], v[232:235], v[112:115], v[136:139]
    s_waitcnt lgkmcnt(4)
    v_mfma_f32_16x16x32_bf16 v[136:139], v[248:251], v[116:119], v[136:139]
    s_waitcnt lgkmcnt(2)
    v_mfma_f32_16x16x32_bf16 v[140:143], v[236:239], v[112:115], v[140:143]
    s_waitcnt lgkmcnt(0)
    v_mfma_f32_16x16x32_bf16 v[140:143], v[252:255], v[116:119], v[140:143]
    v_readfirstlane_b32 s16, v28
    s_waitcnt vmcnt(6)
    s_cmp_ge_u32 s16, 2
    s_cbranch_scc1 L_sn115
    s_waitcnt vmcnt(5)
    s_cmp_ge_u32 s16, 1
    s_cbranch_scc1 L_sn115
    s_waitcnt vmcnt(4)
L_sn115:
    buffer_load_dwordx4 v7, s[24:27], s61 offen offset:3072 nt lds
    v_mov_b32 v29, 1
    s_mov_b64 exec, 1
    ds_add_u32 v31, v29 offset:8
    s_mov_b64 exec, -1
    s_waitcnt vmcnt(6)
    s_cmp_ge_u32 s16, 2
    s_cbranch_scc1 L_sn116
    s_waitcnt vmcnt(5)
    s_cmp_ge_u32 s16, 1
    s_cbranch_scc1 L_sn116
    s_waitcnt vmcnt(4)
L_sn116:
    s_add_u32 m0, s56, 4096
    s_add_u32 s61, s55, 196608
    buffer_load_dwordx4 v6, s[24:27], s61 offen offset:0 nt lds
    s_waitcnt vmcnt(6)
    s_cmp_ge_u32 s16, 2
    s_cbranch_scc1 L_sn117
    s_waitcnt vmcnt(5)
    s_cmp_ge_u32 s16, 1
    s_cbranch_scc1 L_sn117
    s_waitcnt vmcnt(4)
L_sn117:
    buffer_load_dwordx4 v7, s[24:27], s61 offen offset:1024 nt lds
    s_waitcnt vmcnt(6)
    s_cmp_ge_u32 s16, 2
    s_cbranch_scc1 L_sn118
    s_waitcnt vmcnt(5)
    s_cmp_ge_u32 s16, 1
    s_cbranch_scc1 L_sn118
    s_waitcnt vmcnt(4)
L_sn118:
    buffer_load_dwordx4 v6, s[24:27], s61 offen offset:2048 nt lds
    s_waitcnt vmcnt(6)
    s_cmp_ge_u32 s16, 2
    s_cbranch_scc1 L_sn119
    s_waitcnt vmcnt(5)
    s_cmp_ge_u32 s16, 1
    s_cbranch_scc1 L_sn119
    s_waitcnt vmcnt(4)
L_sn119:
    buffer_load_dwordx4 v7, s[24:27], s61 offen offset:3072 nt lds
    s_waitcnt vmcnt(6)
    s_cmp_ge_u32 s16, 2
    s_cbranch_scc1 L_sn120
    s_waitcnt vmcnt(5)
    s_cmp_ge_u32 s16, 1
    s_cbranch_scc1 L_sn120
    s_waitcnt vmcnt(4)
L_sn120:
    s_add_u32 m0, s56, 8192
    s_add_u32 s61, s55, 200704
    buffer_load_dwordx4 v6, s[24:27], s61 offen offset:0 nt lds
    s_waitcnt vmcnt(6)
    s_cmp_ge_u32 s16, 2
    s_cbranch_scc1 L_sn121
    s_waitcnt vmcnt(5)
    s_cmp_ge_u32 s16, 1
    s_cbranch_scc1 L_sn121
    s_waitcnt vmcnt(4)
L_sn121:
    buffer_load_dwordx4 v7, s[24:27], s61 offen offset:1024 nt lds
    s_waitcnt vmcnt(6)
    s_cmp_ge_u32 s16, 2
    s_cbranch_scc1 L_sn122
    s_waitcnt vmcnt(5)
    s_cmp_ge_u32 s16, 1
    s_cbranch_scc1 L_sn122
    s_waitcnt vmcnt(4)
L_sn122:
    buffer_load_dwordx4 v6, s[24:27], s61 offen offset:2048 nt lds
    ds_read_b32 v28, v31 offset:20
    ds_read_b64_tr_b16 v[224:225], v12 offset:0
    ds_read_b64_tr_b16 v[226:227], v12 offset:12288
    ds_read_b64_tr_b16 v[240:241], v16 offset:0
    ds_read_b64_tr_b16 v[242:243], v16 offset:12288
    ds_read_b64_tr_b16 v[228:229], v13 offset:0
    ds_read_b64_tr_b16 v[230:231], v13 offset:12288
    ds_read_b64_tr_b16 v[244:245], v17 offset:0
    ds_read_b64_tr_b16 v[246:247], v17 offset:12288
    ds_read_b64_tr_b16 v[232:233], v14 offset:0
    ds_read_b64_tr_b16 v[234:235], v14 offset:12288
    ds_read_b64_tr_b16 v[248:249], v18 offset:0
    ds_read_b64_tr_b16 v[250:251], v18 offset:12288
    ds_read_b64_tr_b16 v[236:237], v15 offset:0
    ds_read_b64_tr_b16 v[238:239], v15 offset:12288
    ds_read_b64_tr_b16 v[252:253], v19 offset:0
    ds_read_b64_tr_b16 v[254:255], v19 offset:12288
    s_waitcnt lgkmcnt(14)
    v_mfma_f32_16x16x32_bf16 v[128:131], v[224:227], v[48:51], v[128:131]
    s_waitcnt lgkmcnt(12)
    v_mfma_f32_16x16x32_bf16 v[128:131], v[240:243], v[52:55], v[128:131]
    s_waitcnt lgkmcnt(10)
    v_mfma_f32_16x16x32_bf16 v[132:135], v[228:231], v[48:51], v[132:135]
    s_waitcnt lgkmcnt(8)
    v_mfma_f32_16x16x32_bf16 v[132:135], v[244:247], v[52:55], v[132:135]
    s_waitcnt lgkmcnt(6)
    v_mfma_f32_16x16x32_bf16 v[136:139], v[232:235], v[48:51], v[136:139]
    s_waitcnt lgkmcnt(4)
    v_mfma_f32_16x16x32_bf16 v[136:139], v[248:251], v[52:55], v[136:139]
    s_waitcnt lgkmcnt(2)
    v_mfma_f32_16x16x32_bf16 v[140:143], v[236:239], v[48:51], v[140:143]
    s_waitcnt lgkmcnt(0)
    v_mfma_f32_16x16x32_bf16 v[140:143], v[252:255], v[52:55], v[140:143]
    v_readfirstlane_b32 s16, v28
    s_waitcnt vmcnt(6)
    s_cmp_ge_u32 s16, 2
    s_cbranch_scc1 L_sn123
    s_waitcnt vmcnt(5)
    s_cmp_ge_u32 s16, 1
    s_cbranch_scc1 L_sn123
    s_waitcnt vmcnt(4)
L_sn123:
    buffer_load_dwordx4 v7, s[24:27], s61 offen offset:3072 nt lds
    s_waitcnt vmcnt(6)
    s_cmp_ge_u32 s16, 2
    s_cbranch_scc1 L_sn124
    s_waitcnt vmcnt(5)
    s_cmp_ge_u32 s16, 1
    s_cbranch_scc1 L_sn124
    s_waitcnt vmcnt(4)
L_sn124:
    s_add_u32 m0, s56, 0
    s_add_u32 s61, s55, 229376
    buffer_load_dwordx4 v6, s[24:27], s61 offen offset:0 nt lds
    s_waitcnt vmcnt(6)
    s_cmp_ge_u32 s16, 2
    s_cbranch_scc1 L_sn125
    s_waitcnt vmcnt(5)
    s_cmp_ge_u32 s16, 1
    s_cbranch_scc1 L_sn125
    s_waitcnt vmcnt(4)
L_sn125:
    buffer_load_dwordx4 v7, s[24:27], s61 offen offset:1024 nt lds
    s_waitcnt vmcnt(6)
    s_cmp_ge_u32 s16, 2
    s_cbranch_scc1 L_sn126
    s_waitcnt vmcnt(5)
    s_cmp_ge_u32 s16, 1
    s_cbranch_scc1 L_sn126
    s_waitcnt vmcnt(4)
L_sn126:
    buffer_load_dwordx4 v6, s[24:27], s61 offen offset:2048 nt lds
    s_waitcnt vmcnt(6)
    s_cmp_ge_u32 s16, 2
    s_cbranch_scc1 L_sn127
    s_waitcnt vmcnt(5)
    s_cmp_ge_u32 s16, 1
    s_cbranch_scc1 L_sn127
    s_waitcnt vmcnt(4)
L_sn127:
    buffer_load_dwordx4 v7, s[24:27], s61 offen offset:3072 nt lds
    s_waitcnt vmcnt(6)
    s_cmp_ge_u32 s16, 2
    s_cbranch_scc1 L_sn128
    s_waitcnt vmcnt(5)
    s_cmp_ge_u32 s16, 1
    s_cbranch_scc1 L_sn128
    s_waitcnt vmcnt(4)
L_sn128:
    s_add_u32 m0, s56, 12288
    s_add_u32 s61, s55, 233472
    buffer_load_dwordx4 v6, s[24:27], s61 offen offset:0 nt lds
    s_waitcnt vmcnt(6)
    s_cmp_ge_u32 s16, 2
    s_cbranch_scc1 L_sn129
    s_waitcnt vmcnt(5)
    s_cmp_ge_u32 s16, 1
    s_cbranch_scc1 L_sn129
    s_waitcnt vmcnt(4)
L_sn129:
    buffer_load_dwordx4 v7, s[24:27], s61 offen offset:1024 nt lds
    s_waitcnt vmcnt(6)
    s_cmp_ge_u32 s16, 2
    s_cbranch_scc1 L_sn130
    s_waitcnt vmcnt(5)
    s_cmp_ge_u32 s16, 1
    s_cbranch_scc1 L_sn130
    s_waitcnt vmcnt(4)
L_sn130:
    buffer_load_dwordx4 v6, s[24:27], s61 offen offset:2048 nt lds
    ds_read_b32 v28, v31 offset:20
    ds_read_b64_tr_b16 v[224:225], v12 offset:4096
    ds_read_b64_tr_b16 v[226:227], v12 offset:8192
    ds_read_b64_tr_b16 v[240:241], v16 offset:4096
    ds_read_b64_tr_b16 v[242:243], v16 offset:8192
    ds_read_b64_tr_b16 v[228:229], v13 offset:4096
    ds_read_b64_tr_b16 v[230:231], v13 offset:8192
    ds_read_b64_tr_b16 v[244:245], v17 offset:4096
    ds_read_b64_tr_b16 v[246:247], v17 offset:8192
    ds_read_b64_tr_b16 v[232:233], v14 offset:4096
    ds_read_b64_tr_b16 v[234:235], v14 offset:8192
    ds_read_b64_tr_b16 v[248:249], v18 offset:4096
    ds_read_b64_tr_b16 v[250:251], v18 offset:8192
    ds_read_b64_tr_b16 v[236:237], v15 offset:4096
    ds_read_b64_tr_b16 v[238:239], v15 offset:8192
    ds_read_b64_tr_b16 v[252:253], v19 offset:4096
    ds_read_b64_tr_b16 v[254:255], v19 offset:8192
    s_waitcnt lgkmcnt(14)
    v_mfma_f32_16x16x32_bf16 v[128:131], v[224:227], v[64:67], v[128:131]
    s_waitcnt lgkmcnt(12)
    v_mfma_f32_16x16x32_bf16 v[128:131], v[240:243], v[68:71], v[128:131]
    s_waitcnt lgkmcnt(10)
    v_mfma_f32_16x16x32_bf16 v[132:135], v[228:231], v[64:67], v[132:135]
    s_waitcnt lgkmcnt(8)
    v_mfma_f32_16x16x32_bf16 v[132:135], v[244:247], v[68:71], v[132:135]
    s_waitcnt lgkmcnt(6)
    v_mfma_f32_16x16x32_bf16 v[136:139], v[232:235], v[64:67], v[136:139]
    s_waitcnt lgkmcnt(4)
    v_mfma_f32_16x16x32_bf16 v[136:139], v[248:251], v[68:71], v[136:139]
    s_waitcnt lgkmcnt(2)
    v_mfma_f32_16x16x32_bf16 v[140:143], v[236:239], v[64:67], v[140:143]
    s_waitcnt lgkmcnt(0)
    v_mfma_f32_16x16x32_bf16 v[140:143], v[252:255], v[68:71], v[140:143]
    v_readfirstlane_b32 s16, v28
    s_waitcnt vmcnt(6)
    s_cmp_ge_u32 s16, 2
    s_cbranch_scc1 L_sn131
    s_waitcnt vmcnt(5)
    s_cmp_ge_u32 s16, 1
    s_cbranch_scc1 L_sn131
    s_waitcnt vmcnt(4)
L_sn131:
    buffer_load_dwordx4 v7, s[24:27], s61 offen offset:3072 nt lds
    s_waitcnt vmcnt(6)
    s_cmp_ge_u32 s16, 2
    s_cbranch_scc1 L_sn132
    s_waitcnt vmcnt(5)
    s_cmp_ge_u32 s16, 1
    s_cbranch_scc1 L_sn132
    s_waitcnt vmcnt(4)
L_sn132:
    s_add_u32 m0, s56, 4096
    s_add_u32 s61, s97, 262144
    buffer_load_dwordx4 v6, s[24:27], s61 offen offset:0 nt lds
    s_waitcnt vmcnt(6)
    s_cmp_ge_u32 s16, 2
    s_cbranch_scc1 L_sn133
    s_waitcnt vmcnt(5)
    s_cmp_ge_u32 s16, 1
    s_cbranch_scc1 L_sn133
    s_waitcnt vmcnt(4)
L_sn133:
    buffer_load_dwordx4 v7, s[24:27], s61 offen offset:1024 nt lds
    s_waitcnt vmcnt(6)
    s_cmp_ge_u32 s16, 2
    s_cbranch_scc1 L_sn134
    s_waitcnt vmcnt(5)
    s_cmp_ge_u32 s16, 1
    s_cbranch_scc1 L_sn134
    s_waitcnt vmcnt(4)
L_sn134:
    buffer_load_dwordx4 v6, s[24:27], s61 offen offset:2048 nt lds
    s_waitcnt vmcnt(6)
    s_cmp_ge_u32 s16, 2
    s_cbranch_scc1 L_sn135
    s_waitcnt vmcnt(5)
    s_cmp_ge_u32 s16, 1
    s_cbranch_scc1 L_sn135
    s_waitcnt vmcnt(4)
L_sn135:
    buffer_load_dwordx4 v7, s[24:27], s61 offen offset:3072 nt lds
    s_waitcnt vmcnt(4)
    ds_read_b32 v28, v31 offset:20
    ds_read_b64_tr_b16 v[224:225], v12 offset:0
    ds_read_b64_tr_b16 v[226:227], v12 offset:12288
    ds_read_b64_tr_b16 v[240:241], v16 offset:0
    ds_read_b64_tr_b16 v[242:243], v16 offset:12288
    ds_read_b64_tr_b16 v[228:229], v13 offset:0
    ds_read_b64_tr_b16 v[230:231], v13 offset:12288
    ds_read_b64_tr_b16 v[244:245], v17 offset:0
    ds_read_b64_tr_b16 v[246:247], v17 offset:12288
    ds_read_b64_tr_b16 v[232:233], v14 offset:0
    ds_read_b64_tr_b16 v[234:235], v14 offset:12288
    ds_read_b64_tr_b16 v[248:249], v18 offset:0
    ds_read_b64_tr_b16 v[250:251], v18 offset:12288
    ds_read_b64_tr_b16 v[236:237], v15 offset:0
    ds_read_b64_tr_b16 v[238:239], v15 offset:12288
    ds_read_b64_tr_b16 v[252:253], v19 offset:0
    ds_read_b64_tr_b16 v[254:255], v19 offset:12288
    s_waitcnt lgkmcnt(14)
    v_mfma_f32_16x16x32_bf16 v[128:131], v[224:227], v[80:83], v[128:131]
    s_waitcnt lgkmcnt(12)
    v_mfma_f32_16x16x32_bf16 v[128:131], v[240:243], v[84:87], v[128:131]
    s_waitcnt lgkmcnt(10)
    v_mfma_f32_16x16x32_bf16 v[132:135], v[228:231], v[80:83], v[132:135]
    s_waitcnt lgkmcnt(8)
    v_mfma_f32_16x16x32_bf16 v[132:135], v[244:247], v[84:87], v[132:135]
    s_waitcnt lgkmcnt(6)
    v_mfma_f32_16x16x32_bf16 v[136:139], v[232:235], v[80:83], v[136:139]
    s_waitcnt lgkmcnt(4)
    v_mfma_f32_16x16x32_bf16 v[136:139], v[248:251], v[84:87], v[136:139]
    s_waitcnt lgkmcnt(2)
    v_mfma_f32_16x16x32_bf16 v[140:143], v[236:239], v[80:83], v[140:143]
    s_waitcnt lgkmcnt(0)
    v_mfma_f32_16x16x32_bf16 v[140:143], v[252:255], v[84:87], v[140:143]
    v_readfirstlane_b32 s16, v28
    s_cmp_ge_u32 s16, 2
    s_cbranch_scc1 L_sn136
    s_waitcnt vmcnt(3)
    s_cmp_ge_u32 s16, 1
    s_cbranch_scc1 L_sn136
    s_waitcnt vmcnt(2)
L_sn136:
    s_add_u32 m0, s56, 24576
    s_add_u32 s61, s96, 0
    buffer_load_dwordx4 v20, s[32:35], s61 offen offset:0 nt lds
    s_waitcnt vmcnt(4)
    s_cmp_ge_u32 s16, 2
    s_cbranch_scc1 L_sn137
    s_waitcnt vmcnt(3)
    s_cmp_ge_u32 s16, 1
    s_cbranch_scc1 L_sn137
    s_waitcnt vmcnt(2)
L_sn137:
    s_add_u32 s61, s96, 15360
    buffer_load_dwordx4 v20, s[32:35], s61 offen offset:1024 nt lds
    s_waitcnt vmcnt(2)
    ds_read_b64_tr_b16 v[224:225], v12 offset:4096
    ds_read_b64_tr_b16 v[226:227], v16 offset:4096
    ds_read_b64_tr_b16 v[228:229], v13 offset:4096
    ds_read_b64_tr_b16 v[230:231], v17 offset:4096
    ds_read_b64_tr_b16 v[232:233], v14 offset:4096
    ds_read_b64_tr_b16 v[234:235], v18 offset:4096
    ds_read_b64_tr_b16 v[236:237], v15 offset:4096
    ds_read_b64_tr_b16 v[238:239], v19 offset:4096
    s_add_u32 s61, s96, 30720
    buffer_load_dwordx4 v20, s[32:35], s61 offen offset:2048 nt lds
    s_add_u32 s61, s96, 46080
    buffer_load_dwordx4 v20, s[32:35], s61 offen offset:3072 nt lds
    s_waitcnt lgkmcnt(6)
    v_mfma_f32_16x16x32_bf16 v[128:131], v[224:227], v[96:99], v[128:131]
    s_waitcnt lgkmcnt(4)
    v_mfma_f32_16x16x32_bf16 v[132:135], v[228:231], v[96:99], v[132:135]
    s_waitcnt lgkmcnt(2)
    v_mfma_f32_16x16x32_bf16 v[136:139], v[232:235], v[96:99], v[136:139]
    s_waitcnt lgkmcnt(0)
    v_mfma_f32_16x16x32_bf16 v[140:143], v[236:239], v[96:99], v[140:143]
L_tail:
    s_nop 1
    ds_write_b128 v212, v[128:131] offset:0
    s_nop 0
    ds_write_b128 v212, v[132:135] offset:64
    s_nop 0
    ds_write_b128 v212, v[136:139] offset:128
    s_nop 0
    ds_write_b128 v212, v[140:143] offset:192
    s_waitcnt lgkmcnt(0)
    s_barrier
    ds_read_b128 v[32:35], v214
    ds_read_b128 v[128:131], v213 offset:0
    ds_read_b128 v[132:135], v213 offset:4224
    ds_read_b128 v[136:139], v213 offset:8448
    ds_read_b128 v[140:143], v213 offset:12672
    s_waitcnt lgkmcnt(3)
    v_pk_mul_f32 v[120:121], v[128:129], v[32:33] op_sel:[0,0] op_sel_hi:[1,0]
    v_pk_mul_f32 v[122:123], v[130:131], v[32:33] op_sel:[0,0] op_sel_hi:[1,0]
    s_waitcnt lgkmcnt(2)
    v_pk_fma_f32 v[120:121], v[132:133], v[32:33], v[120:121] op_sel:[0,1,0] op_sel_hi:[1,1,1]
    v_pk_fma_f32 v[122:123], v[134:135], v[32:33], v[122:123] op_sel:[0,1,0] op_sel_hi:[1,1,1]
    s_waitcnt lgkmcnt(1)
    v_pk_fma_f32 v[120:121], v[136:137], v[34:35], v[120:121] op_sel:[0,0,0] op_sel_hi:[1,0,1]
    v_pk_fma_f32 v[122:123], v[138:139], v[34:35], v[122:123] op_sel:[0,0,0] op_sel_hi:[1,0,1]
    s_waitcnt lgkmcnt(0)
    v_pk_fma_f32 v[120:121], v[140:141], v[34:35], v[120:121] op_sel:[0,1,0] op_sel_hi:[1,1,1]
    v_pk_fma_f32 v[122:123], v[142:143], v[34:35], v[122:123] op_sel:[0,1,0] op_sel_hi:[1,1,1]
    v_max3_f32 v22, |v120|, |v121|, |v122|
    v_max_f32 v22, |v123|, v22
    s_nop 1
    v_max_f32_dpp v22, v22, v22 quad_perm:[1,0,3,2] row_mask:0xf bank_mask:0xf
    v_and_b32 v23, 0x7f800000, v22
    v_sub_u32 v22, 0x7e800100, v23
    v_lshrrev_b32 v23, 23, v23
    v_pk_fma_f32 v[120:121], v[120:121], v[22:23], v[198:199] op_sel_hi:[1,0,0]
    v_pk_fma_f32 v[122:123], v[122:123], v[22:23], v[196:197] op_sel_hi:[1,0,0]
    v_sub_u32 v23, v23, 14 clamp
    v_cvt_pknorm_i16_f32 v120, v120, v121
    v_cvt_pknorm_i16_f32 v121, v122, v123
    v_mad_u32_u24 v23, v23, v201, v202
    v_bfi_b32 v121, v195, v203, v121
    v_bfi_b32 v120, v200, v23, v120
    buffer_store_dwordx2 v[120:121], v215, s[40:43], 0 offen sc1
    s_add_u32 m0, s56, 28672
    s_add_u32 s61, s96, 8192
    buffer_load_dwordx4 v20, s[32:35], s61 offen offset:0 nt lds
    s_add_u32 s61, s96, 23552
    buffer_load_dwordx4 v20, s[32:35], s61 offen offset:1024 nt lds
    s_add_u32 s61, s96, 38912
    buffer_load_dwordx4 v20, s[32:35], s61 offen offset:2048 nt lds
    s_add_u32 s61, s96, 54272
    buffer_load_dwordx4 v20, s[32:35], s61 offen offset:3072 nt lds
    s_mov_b64 exec, 0xff
    buffer_load_dword v223, v222, s[40:43], s98 offen sc1
    s_mov_b64 exec, -1
    ds_read_b32 v28, v31 offset:28
    s_waitcnt lgkmcnt(0)
    v_readfirstlane_b32 s17, v28
    s_waitcnt vmcnt(1)
    s_barrier
    buffer_load_dwordx4 v[224:227], v216, s[40:43], s66 offen sc1
    buffer_load_dwordx4 v[228:231], v216, s[40:43], s67 offen sc1
    buffer_load_dwordx4 v[232:235], v216, s[40:43], s68 offen sc1
    buffer_load_dwordx4 v[236:239], v216, s[40:43], s69 offen sc1
    ds_read_b64_tr_b16 v[160:161], v21 offset:0
    ds_read_b64_tr_b16 v[162:163], v21 offset:4096
    ds_read_b64_tr_b16 v[164:165], v21 offset:8
    ds_read_b64_tr_b16 v[166:167], v21 offset:4104
    ds_read_b64_tr_b16 v[168:169], v21 offset:32768
    ds_read_b64_tr_b16 v[170:171], v21 offset:36864
    ds_read_b64_tr_b16 v[172:173], v21 offset:32776
    ds_read_b64_tr_b16 v[174:175], v21 offset:36872
    ds_read_b64_tr_b16 v[176:177], v217 offset:0
    ds_read_b64_tr_b16 v[178:179], v217 offset:4096
    ds_read_b64_tr_b16 v[180:181], v217 offset:8
    ds_read_b64_tr_b16 v[182:183], v217 offset:4104
    ds_read_b64_tr_b16 v[184:185], v217 offset:32768
    ds_read_b64_tr_b16 v[186:187], v217 offset:36864
    ds_read_b64_tr_b16 v[188:189], v217 offset:32776
    ds_read_b64_tr_b16 v[190:191], v217 offset:36872
    s_waitcnt vmcnt(3)
    v_xor_b32 v225, s99, v225
    v_xor_b32 v226, s100, v226
    v_xor_b32 v227, s101, v227
    v_or3_b32 v24, v225, v226, v227
    v_and_b32 v23, s3, v224
    v_mul_u32_u24 v204, 0x800800, v23
    v_xor_b32 v224, v224, v23
    v_and_b32 v204, 0x7f800000, v204
    v_cvt_f32_i32_sdwa v128, sext(v224) dst_sel:DWORD dst_unused:UNUSED_PAD src0_sel:WORD_0
    v_cvt_f32_i32_sdwa v129, sext(v224) dst_sel:DWORD dst_unused:UNUSED_PAD src0_sel:WORD_1
    v_cvt_f32_i32_sdwa v130, sext(v225) dst_sel:DWORD dst_unused:UNUSED_PAD src0_sel:WORD_0
    v_cvt_f32_i32_sdwa v131, sext(v225) dst_sel:DWORD dst_unused:UNUSED_PAD src0_sel:WORD_1
    v_cvt_f32_i32_sdwa v132, sext(v226) dst_sel:DWORD dst_unused:UNUSED_PAD src0_sel:WORD_0
    v_cvt_f32_i32_sdwa v133, sext(v226) dst_sel:DWORD dst_unused:UNUSED_PAD src0_sel:WORD_1
    v_cvt_f32_i32_sdwa v134, sext(v227) dst_sel:DWORD dst_unused:UNUSED_PAD src0_sel:WORD_0
    v_cvt_f32_i32_sdwa v135, sext(v227) dst_sel:DWORD dst_unused:UNUSED_PAD src0_sel:WORD_1
    s_waitcnt vmcnt(2)
    v_xor_b32 v229, s99, v229
    v_xor_b32 v230, s100, v230
    v_xor_b32 v231, s101, v231
    v_or3_b32 v25, v229, v230, v231
    v_and_b32 v23, s3, v228
    v_mul_u32_u24 v205, 0x800800, v23
    v_xor_b32 v228, v228, v23
    v_and_b32 v205, 0x7f800000, v205
    v_cvt_f32_i32_sdwa v136, sext(v228) dst_sel:DWORD dst_unused:UNUSED_PAD src0_sel:WORD_0
    v_cvt_f32_i32_sdwa v137, sext(v228) dst_sel:DWORD dst_unused:UNUSED_PAD src0_sel:WORD_1
    v_cvt_f32_i32_sdwa v138, sext(v229) dst_sel:DWORD dst_unused:UNUSED_PAD src0_sel:WORD_0
    v_cvt_f32_i32_sdwa v139, sext(v229) dst_sel:DWORD dst_unused:UNUSED_PAD src0_sel:WORD_1
    v_cvt_f32_i32_sdwa v140, sext(v230) dst_sel:DWORD dst_unused:UNUSED_PAD src0_sel:WORD_0
    v_cvt_f32_i32_sdwa v141, sext(v230) dst_sel:DWORD dst_unused:UNUSED_PAD src0_sel:WORD_1
    v_cvt_f32_i32_sdwa v142, sext(v231) dst_sel:DWORD dst_unused:UNUSED_PAD src0_sel:WORD_0
    v_cvt_f32_i32_sdwa v143, sext(v231) dst_sel:DWORD dst_unused:UNUSED_PAD src0_sel:WORD_1
    s_waitcnt vmcnt(1)
    v_xor_b32 v233, s99, v233
    v_xor_b32 v234, s100, v234
    v_xor_b32 v235, s101, v235
    v_or3_b32 v26, v233, v234, v235
    v_and_b32 v23, s3, v232
    v_mul_u32_u24 v206, 0x800800, v23
    v_xor_b32 v232, v232, v23
    v_and_b32 v206, 0x7f800000, v206
    v_cvt_f32_i32_sdwa v144, sext(v232) dst_sel:DWORD dst_unused:UNUSED_PAD src0_sel:WORD_0
    v_cvt_f32_i32_sdwa v145, sext(v232) dst_sel:DWORD dst_unused:UNUSED_PAD src0_sel:WORD_1
    v_cvt_f32_i32_sdwa v146, sext(v233) dst_sel:DWORD dst_unused:UNUSED_PAD src0_sel:WORD_0
    v_cvt_f32_i32_sdwa v147, sext(v233) dst_sel:DWORD dst_unused:UNUSED_PAD src0_sel:WORD_1
    v_cvt_f32_i32_sdwa v148, sext(v234) dst_sel:DWORD dst_unused:UNUSED_PAD src0_sel:WORD_0
    v_cvt_f32_i32_sdwa v149, sext(v234) dst_sel:DWORD dst_unused:UNUSED_PAD src0_sel:WORD_1
    v_cvt_f32_i32_sdwa v150, sext(v235) dst_sel:DWORD dst_unused:UNUSED_PAD src0_sel:WORD_0
    v_cvt_f32_i32_sdwa v151, sext(v235) dst_sel:DWORD dst_unused:UNUSED_PAD src0_sel:WORD_1
    s_waitcnt vmcnt(0)
    v_xor_b32 v237, s99, v237
    v_xor_b32 v238, s100, v238
    v_xor_b32 v239, s101, v239
    v_or3_b32 v27, v237, v238, v239
    v_or3_b32 v22, v24, v25, v26
    v_or_b32 v22, v22, v27
    v_and_b32 v22, 0x00070007, v22
    v_cmp_ne_u32 vcc, 0, v22
    v_and_b32 v23, s3, v236
    v_mul_u32_u24 v207, 0x800800, v23
    v_xor_b32 v236, v236, v23
    v_and_b32 v207, 0x7f800000, v207
    v_cvt_f32_i32_sdwa v152, sext(v236) dst_sel:DWORD dst_unused:UNUSED_PAD src0_sel:WORD_0
    v_cvt_f32_i32_sdwa v153, sext(v236) dst_sel:DWORD dst_unused:UNUSED_PAD src0_sel:WORD_1
    v_cvt_f32_i32_sdwa v154, sext(v237) dst_sel:DWORD dst_unused:UNUSED_PAD src0_sel:WORD_0
    v_cvt_f32_i32_sdwa v155, sext(v237) dst_sel:DWORD dst_unused:UNUSED_PAD src0_sel:WORD_1
    v_cvt_f32_i32_sdwa v156, sext(v238) dst_sel:DWORD dst_unused:UNUSED_PAD src0_sel:WORD_0
    v_cvt_f32_i32_sdwa v157, sext(v238) dst_sel:DWORD dst_unused:UNUSED_PAD src0_sel:WORD_1
    v_cvt_f32_i32_sdwa v158, sext(v239) dst_sel:DWORD dst_unused:UNUSED_PAD src0_sel:WORD_0
    v_cvt_f32_i32_sdwa v159, sext(v239) dst_sel:DWORD dst_unused:UNUSED_PAD src0_sel:WORD_1
    s_cmp_lg_u64 vcc, 0
    s_cbranch_scc1 L_p1_miss
L_p1_done:
    v_pk_mul_f32 v[120:121], v[128:129], v[204:205] op_sel:[0,0] op_sel_hi:[1,0]
    v_pk_mul_f32 v[122:123], v[130:131], v[204:205] op_sel:[0,0] op_sel_hi:[1,0]
    v_pk_mul_f32 v[124:125], v[132:133], v[204:205] op_sel:[0,0] op_sel_hi:[1,0]
    v_pk_mul_f32 v[126:127], v[134:135], v[204:205] op_sel:[0,0] op_sel_hi:[1,0]
    v_pk_fma_f32 v[120:121], v[136:137], v[204:205], v[120:121] op_sel:[0,1,0] op_sel_hi:[1,1,1]
    v_pk_fma_f32 v[122:123], v[138:139], v[204:205], v[122:123] op_sel:[0,1,0] op_sel_hi:[1,1,1]
    v_pk_fma_f32 v[124:125], v[140:141], v[204:205], v[124:125] op_sel:[0,1,0] op_sel_hi:[1,1,1]
    v_pk_fma_f32 v[126:127], v[142:143], v[204:205], v[126:127] op_sel:[0,1,0] op_sel_hi:[1,1,1]
    v_pk_fma_f32 v[120:121], v[144:145], v[206:207], v[120:121] op_sel:[0,0,0] op_sel_hi:[1,0,1]
    v_pk_fma_f32 v[122:123], v[146:147], v[206:207], v[122:123] op_sel:[0,0,0] op_sel_hi:[1,0,1]
    v_pk_fma_f32 v[124:125], v[148:149], v[206:207], v[124:125] op_sel:[0,0,0] op_sel_hi:[1,0,1]
    v_pk_fma_f32 v[126:127], v[150:151], v[206:207], v[126:127] op_sel:[0,0,0] op_sel_hi:[1,0,1]
    v_pk_fma_f32 v[120:121], v[152:153], v[206:207], v[120:121] op_sel:[0,1,0] op_sel_hi:[1,1,1]
    v_pk_fma_f32 v[122:123], v[154:155], v[206:207], v[122:123] op_sel:[0,1,0] op_sel_hi:[1,1,1]
    v_pk_fma_f32 v[124:125], v[156:157], v[206:207], v[124:125] op_sel:[0,1,0] op_sel_hi:[1,1,1]
    v_pk_fma_f32 v[126:127], v[158:159], v[206:207], v[126:127] op_sel:[0,1,0] op_sel_hi:[1,1,1]
    v_cvt_pk_bf16_f32 v120, v120, v121
    v_cvt_pk_bf16_f32 v121, v122, v123
    v_cvt_pk_bf16_f32 v122, v124, v125
    v_cvt_pk_bf16_f32 v123, v126, v127
    ds_write_b128 v192, v[120:123]
    s_waitcnt lgkmcnt(0)
    s_barrier
    ds_read_b128 v[32:35], v208
    ds_read_b128 v[36:39], v209
    ds_read_b128 v[40:43], v210
    ds_read_b128 v[44:47], v211
    s_waitcnt lgkmcnt(3)
    v_mfma_f32_16x16x32_bf16 v[120:123], v[160:163], v[32:35], 0
    v_mfma_f32_16x16x32_bf16 v[124:127], v[164:167], v[32:35], 0
    s_waitcnt lgkmcnt(2)
    v_mfma_f32_16x16x32_bf16 v[120:123], v[168:171], v[36:39], v[120:123]
    v_mfma_f32_16x16x32_bf16 v[124:127], v[172:175], v[36:39], v[124:127]
    s_waitcnt lgkmcnt(1)
    v_mfma_f32_16x16x32_bf16 v[120:123], v[176:179], v[40:43], v[120:123]
    v_mfma_f32_16x16x32_bf16 v[124:127], v[180:183], v[40:43], v[124:127]
    s_waitcnt lgkmcnt(0)
    v_mfma_f32_16x16x32_bf16 v[120:123], v[184:187], v[44:47], v[120:123]
    v_mfma_f32_16x16x32_bf16 v[124:127], v[188:191], v[44:47], v[124:127]
    s_bitcmp1_b32 s17, 0
    s_nop 5
    v_max3_f32 v22, |v120|, |v121|, |v122|
    v_max3_f32 v23, |v124|, |v125|, |v126|
    v_max3_f32 v22, v22, |v123|, |v127|
    v_max_f32 v22, v22, v23
    v_and_b32 v23, 0x7f800000, v22
    v_sub_u32 v22, 0x7e800100, v23
    v_lshrrev_b32 v23, 23, v23
    v_sub_u32 v23, v23, 14 clamp
    v_pk_fma_f32 v[120:121], v[120:121], v[22:23], v[194:195] op_sel_hi:[1,0,0]
    v_pk_fma_f32 v[122:123], v[122:123], v[22:23], v[196:197] op_sel_hi:[1,0,0]
    v_pk_fma_f32 v[124:125], v[124:125], v[22:23], v[196:197] op_sel_hi:[1,0,0]
    v_pk_fma_f32 v[126:127], v[126:127], v[22:23], v[196:197] op_sel_hi:[1,0,0]
    v_mul_u32_u24 v23, 0x1001, v23
    v_cvt_pknorm_i16_f32 v128, v120, v121
    v_cvt_pknorm_i16_f32 v129, v122, v123
    v_cvt_pknorm_i16_f32 v130, v124, v125
    v_cvt_pknorm_i16_f32 v131, v126, v127
    v_bfi_b32 v128, s3, v23, v128
    v_bfi_b32 v129, v195, s99, v129
    v_bfi_b32 v130, v195, s100, v130
    v_bfi_b32 v131, v195, s101, v131
    s_cbranch_scc0 L_p2_far
    buffer_store_dwordx4 v[128:131], v218, s[40:43], 0 offen
L_p2_sent:
    s_waitcnt vmcnt(0)
L_p2:
    buffer_load_dwordx4 v[224:227], v219, s[40:43], s70 offen sc1
    s_waitcnt vmcnt(0)
    v_xor_b32 v225, s99, v225
    v_xor_b32 v226, s100, v226
    v_xor_b32 v227, s101, v227
    v_or3_b32 v22, v225, v226, v227
    v_and_b32 v22, 0x00070007, v22
    v_cmp_ne_u32 vcc, 0, v22
    s_wqm_b64 exec, vcc
    s_cbranch_scc0 L_p2_done
    s_add_u32 s63, s63, 1
    s_cmp_lt_u32 s63, 1048576
    s_cbranch_scc1 L_p2
L_p2_done:
    s_mov_b64 exec, -1
    v_and_b32 v23, s3, v224
    v_mul_u32_u24 v22, 0x800800, v23
    v_xor_b32 v224, v224, v23
    v_and_b32 v22, 0x7f800000, v22
    v_cvt_f32_i32_sdwa v120, sext(v224) dst_sel:DWORD dst_unused:UNUSED_PAD src0_sel:WORD_0
    v_cvt_f32_i32_sdwa v121, sext(v224) dst_sel:DWORD dst_unused:UNUSED_PAD src0_sel:WORD_1
    v_cvt_f32_i32_sdwa v122, sext(v225) dst_sel:DWORD dst_unused:UNUSED_PAD src0_sel:WORD_0
    v_cvt_f32_i32_sdwa v123, sext(v225) dst_sel:DWORD dst_unused:UNUSED_PAD src0_sel:WORD_1
    v_cvt_f32_i32_sdwa v124, sext(v226) dst_sel:DWORD dst_unused:UNUSED_PAD src0_sel:WORD_0
    v_cvt_f32_i32_sdwa v125, sext(v226) dst_sel:DWORD dst_unused:UNUSED_PAD src0_sel:WORD_1
    v_cvt_f32_i32_sdwa v126, sext(v227) dst_sel:DWORD dst_unused:UNUSED_PAD src0_sel:WORD_0
    v_cvt_f32_i32_sdwa v127, sext(v227) dst_sel:DWORD dst_unused:UNUSED_PAD src0_sel:WORD_1
    v_pk_mul_f32 v[120:121], v[120:121], v[22:23] op_sel:[0,0] op_sel_hi:[1,0]
    v_pk_mul_f32 v[122:123], v[122:123], v[22:23] op_sel:[0,0] op_sel_hi:[1,0]
    v_pk_mul_f32 v[124:125], v[124:125], v[22:23] op_sel:[0,0] op_sel_hi:[1,0]
    v_pk_mul_f32 v[126:127], v[126:127], v[22:23] op_sel:[0,0] op_sel_hi:[1,0]
    s_nop 0
    v_permlane32_swap_b32 v120, v124
    v_permlane32_swap_b32 v121, v125
    v_permlane32_swap_b32 v122, v126
    v_permlane32_swap_b32 v123, v127
    v_add_f32 v120, v120, v124
    v_add_f32 v121, v121, v125
    v_add_f32 v122, v122, v126
    v_add_f32 v123, v123, v127
    s_nop 0
    v_permlane16_swap_b32 v120, v122
    v_permlane16_swap_b32 v121, v123
    v_add_f32 v120, v120, v122
    v_add_f32 v121, v121, v123
    s_nop 0
    v_add_f32_dpp v120, v120, v120 row_ror:8 row_mask:0xf bank_mask:0xf
    v_add_f32_dpp v121, v121, v121 row_ror:8 row_mask:0xf bank_mask:0xf
    s_nop 0
    v_add_f32_dpp v120, v120, v120 row_ror:4 row_mask:0xf bank_mask:0xf
    v_add_f32_dpp v121, v121, v121 row_ror:4 row_mask:0xf bank_mask:0xf
    s_nop 0
    v_add_f32_dpp v120, v120, v120 row_ror:2 row_mask:0xf bank_mask:0xf
    v_add_f32_dpp v121, v121, v121 row_ror:2 row_mask:0xf bank_mask:0xf
    v_cvt_pk_bf16_f32 v120, v120, v121
    s_mov_b32 exec_lo, 0x00030003
    s_mov_b32 exec_hi, 0x00030003
    buffer_store_dword v120, v220, s[44:47], 0 offen
    s_or_b32 s57, s2, s52
    s_cbranch_scc1 L_noep
    s_mov_b64 exec, 1
    v_mov_b32 v22, s60
    v_mov_b32 v23, 2392064
    buffer_store_dword v22, v23, s[40:43], 0 offen
L_noep:
    s_mov_b64 exec, -1
    s_endpgm
L_p1_miss:
    v_and_b32 v22, 0x00070007, v24
    v_cmp_ne_u32 vcc, 0, v22
    s_wqm_b64 s[4:5], vcc
    v_and_b32 v22, 0x00070007, v25
    v_cmp_ne_u32 vcc, 0, v22
    s_wqm_b64 s[6:7], vcc
    v_and_b32 v22, 0x00070007, v26
    v_cmp_ne_u32 vcc, 0, v22
    s_wqm_b64 s[8:9], vcc
    v_and_b32 v22, 0x00070007, v27
    v_cmp_ne_u32 vcc, 0, v22
    s_wqm_b64 s[10:11], vcc
L_p1:
    s_mov_b64 exec, s[4:5]
    s_cbranch_execz L_p1_l0
    buffer_load_dwordx4 v[224:227], v216, s[40:43], s66 offen sc1
L_p1_l0:
    s_mov_b64 exec, s[6:7]
    s_cbranch_execz L_p1_l1
    buffer_load_dwordx4 v[228:231], v216, s[40:43], s67 offen sc1
L_p1_l1:
    s_mov_b64 exec, s[8:9]
    s_cbranch_execz L_p1_l2
    buffer_load_dwordx4 v[232:235], v216, s[40:43], s68 offen sc1
L_p1_l2:
    s_mov_b64 exec, s[10:11]
    s_cbranch_execz L_p1_l3
    buffer_load_dwordx4 v[236:239], v216, s[40:43], s69 offen sc1
L_p1_l3:
    s_waitcnt vmcnt(0)
    s_mov_b64 exec, s[4:5]
    s_cbranch_execz L_p1_c0
    v_xor_b32 v225, s99, v225
    v_xor_b32 v226, s100, v226
    v_xor_b32 v227, s101, v227
    v_or3_b32 v22, v225, v226, v227
    v_and_b32 v22, 0x00070007, v22
    v_cmp_ne_u32 vcc, 0, v22
    v_and_b32 v23, s3, v224
    v_mul_u32_u24 v204, 0x800800, v23
    v_xor_b32 v224, v224, v23
    v_and_b32 v204, 0x7f800000, v204
    v_cvt_f32_i32_sdwa v128, sext(v224) dst_sel:DWORD dst_unused:UNUSED_PAD src0_sel:WORD_0
    v_cvt_f32_i32_sdwa v129, sext(v224) dst_sel:DWORD dst_unused:UNUSED_PAD src0_sel:WORD_1
    v_cvt_f32_i32_sdwa v130, sext(v225) dst_sel:DWORD dst_unused:UNUSED_PAD src0_sel:WORD_0
    v_cvt_f32_i32_sdwa v131, sext(v225) dst_sel:DWORD dst_unused:UNUSED_PAD src0_sel:WORD_1
    v_cvt_f32_i32_sdwa v132, sext(v226) dst_sel:DWORD dst_unused:UNUSED_PAD src0_sel:WORD_0
    v_cvt_f32_i32_sdwa v133, sext(v226) dst_sel:DWORD dst_unused:UNUSED_PAD src0_sel:WORD_1
    v_cvt_f32_i32_sdwa v134, sext(v227) dst_sel:DWORD dst_unused:UNUSED_PAD src0_sel:WORD_0
    v_cvt_f32_i32_sdwa v135, sext(v227) dst_sel:DWORD dst_unused:UNUSED_PAD src0_sel:WORD_1
    s_wqm_b64 s[4:5], vcc
L_p1_c0:
    s_mov_b64 exec, s[6:7]
    s_cbranch_execz L_p1_c1
    v_xor_b32 v229, s99, v229
    v_xor_b32 v230, s100, v230
    v_xor_b32 v231, s101, v231
    v_or3_b32 v22, v229, v230, v231
    v_and_b32 v22, 0x00070007, v22
    v_cmp_ne_u32 vcc, 0, v22
    v_and_b32 v23, s3, v228
    v_mul_u32_u24 v205, 0x800800, v23
    v_xor_b32 v228, v228, v23
    v_and_b32 v205, 0x7f800000, v205
    v_cvt_f32_i32_sdwa v136, sext(v228) dst_sel:DWORD dst_unused:UNUSED_PAD src0_sel:WORD_0
    v_cvt_f32_i32_sdwa v137, sext(v228) dst_sel:DWORD dst_unused:UNUSED_PAD src0_sel:WORD_1
    v_cvt_f32_i32_sdwa v138, sext(v229) dst_sel:DWORD dst_unused:UNUSED_PAD src0_sel:WORD_0
    v_cvt_f32_i32_sdwa v139, sext(v229) dst_sel:DWORD dst_unused:UNUSED_PAD src0_sel:WORD_1
    v_cvt_f32_i32_sdwa v140, sext(v230) dst_sel:DWORD dst_unused:UNUSED_PAD src0_sel:WORD_0
    v_cvt_f32_i32_sdwa v141, sext(v230) dst_sel:DWORD dst_unused:UNUSED_PAD src0_sel:WORD_1
    v_cvt_f32_i32_sdwa v142, sext(v231) dst_sel:DWORD dst_unused:UNUSED_PAD src0_sel:WORD_0
    v_cvt_f32_i32_sdwa v143, sext(v231) dst_sel:DWORD dst_unused:UNUSED_PAD src0_sel:WORD_1
    s_wqm_b64 s[6:7], vcc
L_p1_c1:
    s_mov_b64 exec, s[8:9]
    s_cbranch_execz L_p1_c2
    v_xor_b32 v233, s99, v233
    v_xor_b32 v234, s100, v234
    v_xor_b32 v235, s101, v235
    v_or3_b32 v22, v233, v234, v235
    v_and_b32 v22, 0x00070007, v22
    v_cmp_ne_u32 vcc, 0, v22
    v_and_b32 v23, s3, v232
    v_mul_u32_u24 v206, 0x800800, v23
    v_xor_b32 v232, v232, v23
    v_and_b32 v206, 0x7f800000, v206
    v_cvt_f32_i32_sdwa v144, sext(v232) dst_sel:DWORD dst_unused:UNUSED_PAD src0_sel:WORD_0
    v_cvt_f32_i32_sdwa v145, sext(v232) dst_sel:DWORD dst_unused:UNUSED_PAD src0_sel:WORD_1
    v_cvt_f32_i32_sdwa v146, sext(v233) dst_sel:DWORD dst_unused:UNUSED_PAD src0_sel:WORD_0
    v_cvt_f32_i32_sdwa v147, sext(v233) dst_sel:DWORD dst_unused:UNUSED_PAD src0_sel:WORD_1
    v_cvt_f32_i32_sdwa v148, sext(v234) dst_sel:DWORD dst_unused:UNUSED_PAD src0_sel:WORD_0
    v_cvt_f32_i32_sdwa v149, sext(v234) dst_sel:DWORD dst_unused:UNUSED_PAD src0_sel:WORD_1
    v_cvt_f32_i32_sdwa v150, sext(v235) dst_sel:DWORD dst_unused:UNUSED_PAD src0_sel:WORD_0
    v_cvt_f32_i32_sdwa v151, sext(v235) dst_sel:DWORD dst_unused:UNUSED_PAD src0_sel:WORD_1
    s_wqm_b64 s[8:9], vcc
L_p1_c2:
    s_mov_b64 exec, s[10:11]
    s_cbranch_execz L_p1_c3
    v_xor_b32 v237, s99, v237
    v_xor_b32 v238, s100, v238
    v_xor_b32 v239, s101, v239
    v_or3_b32 v22, v237, v238, v239
    v_and_b32 v22, 0x00070007, v22
    v_cmp_ne_u32 vcc, 0, v22
    v_and_b32 v23, s3, v236
    v_mul_u32_u24 v207, 0x800800, v23
    v_xor_b32 v236, v236, v23
    v_and_b32 v207, 0x7f800000, v207
    v_cvt_f32_i32_sdwa v152, sext(v236) dst_sel:DWORD dst_unused:UNUSED_PAD src0_sel:WORD_0
    v_cvt_f32_i32_sdwa v153, sext(v236) dst_sel:DWORD dst_unused:UNUSED_PAD src0_sel:WORD_1
    v_cvt_f32_i32_sdwa v154, sext(v237) dst_sel:DWORD dst_unused:UNUSED_PAD src0_sel:WORD_0
    v_cvt_f32_i32_sdwa v155, sext(v237) dst_sel:DWORD dst_unused:UNUSED_PAD src0_sel:WORD_1
    v_cvt_f32_i32_sdwa v156, sext(v238) dst_sel:DWORD dst_unused:UNUSED_PAD src0_sel:WORD_0
    v_cvt_f32_i32_sdwa v157, sext(v238) dst_sel:DWORD dst_unused:UNUSED_PAD src0_sel:WORD_1
    v_cvt_f32_i32_sdwa v158, sext(v239) dst_sel:DWORD dst_unused:UNUSED_PAD src0_sel:WORD_0
    v_cvt_f32_i32_sdwa v159, sext(v239) dst_sel:DWORD dst_unused:UNUSED_PAD src0_sel:WORD_1
    s_wqm_b64 s[10:11], vcc
L_p1_c3:
    s_mov_b64 exec, -1
    s_or_b64 vcc, s[4:5], s[6:7]
    s_or_b64 vcc, vcc, s[8:9]
    s_or_b64 vcc, vcc, s[10:11]
    s_cbranch_scc0 L_p1_done
    s_add_u32 s63, s63, 1
    s_cmp_lt_u32 s63, 1048576
    s_cbranch_scc1 L_p1
    s_branch L_p1_done
L_p2_far:
    buffer_store_dwordx4 v[128:131], v218, s[40:43], 0 offen sc1
    s_branch L_p2_sent
L_qwg:
    v_lshlrev_b32 v28, 4, v25
    v_lshl_or_b32 v28, v26, 11, v28
    s_lshl_b32 s59, s66, 6
    s_mov_b32 s36, s4
    s_mov_b32 s37, s5
    s_mov_b32 s38, 0x8000
    s_mov_b32 s39, 0x20000
    buffer_load_dwordx4 v[32:35], v28, s[36:39], s59 offen offset:0
    buffer_load_dwordx4 v[36:39], v28, s[36:39], s59 offen offset:256
    buffer_load_dwordx4 v[40:43], v28, s[36:39], s59 offen offset:512
    buffer_load_dwordx4 v[44:47], v28, s[36:39], s59 offen offset:768
    buffer_load_dwordx4 v3, s[20:23], s61 offen offset:1024 nt lds
    s_barrier
    s_mov_b32 s28, s6
    s_mov_b32 s29, s7
    s_mov_b32 s30, 0x4000000
    s_mov_b32 s31, 0x20000
    v_and_b32 v28, 7, v26
    s_add_u32 s57, s56, 24576
    v_add_u32 v29, 0, v25
    v_xor_b32 v29, v28, v29
    v_lshlrev_b32 v29, 4, v29
    v_lshl_or_b32 v29, v26, 9, v29
    v_add_u32 v48, s57, v29
    v_add_u32 v29, 4, v25
    v_xor_b32 v29, v28, v29
    v_lshlrev_b32 v29, 4, v29
    v_lshl_or_b32 v29, v26, 9, v29
    v_add_u32 v49, s57, v29
    s_mov_b32 s24, s8
    s_mov_b32 s25, s9
    s_mov_b32 s26, 0x4000000
    s_mov_b32 s27, 0x20000
    s_mov_b32 s32, s12
    s_mov_b32 s33, s13
    s_mov_b32 s34, 0x800000
    s_mov_b32 s35, 0x20000
    s_mov_b32 s40, s18
    s_mov_b32 s41, s19
    s_mov_b32 s42, 0x10000000
    s_mov_b32 s43, 0x20000
    s_mov_b32 s44, s14
    s_mov_b32 s45, s15
    s_mov_b32 s46, 0x8000
    s_mov_b32 s47, 0x20000
    s_mov_b32 s63, 0
    s_mov_b32 s16, 0
    s_mov_b32 s62, 0x3e0293ee
    v_add_u32 v29, 0, v25
    v_lshlrev_b32 v29, 1, v29
    v_xor_b32 v29, v26, v29
    v_lshlrev_b32 v29, 4, v29
    v_lshl_or_b32 v6, v25, 8, v29
    v_add_u32 v29, 4, v25
    v_lshlrev_b32 v29, 1, v29
    v_xor_b32 v29, v26, v29
    v_lshlrev_b32 v29, 4, v29
    v_lshl_or_b32 v7, v25, 8, v29
    v_add_u32 v29, 0, v25
    v_xor_b32 v29, v26, v29
    v_lshlrev_b32 v29, 4, v29
    v_lshl_or_b32 v29, v26, 8, v29
    v_add_u32 v8, s56, v29
    v_add_u32 v29, 4, v25
    v_xor_b32 v29, v26, v29
    v_lshlrev_b32 v29, 4, v29
    v_lshl_or_b32 v29, v26, 8, v29
    v_add_u32 v9, s56, v29
    v_add_u32 v29, 8, v25
    v_xor_b32 v29, v26, v29
    v_lshlrev_b32 v29, 4, v29
    v_lshl_or_b32 v29, v26, 8, v29
    v_add_u32 v10, s56, v29
    v_add_u32 v29, 12, v25
    v_xor_b32 v29, v26, v29
    v_lshlrev_b32 v29, 4, v29
    v_lshl_or_b32 v29, v26, 8, v29
    v_add_u32 v11, s56, v29
    v_lshrrev_b32 v30, 2, v1
    v_and_b32 v31, 3, v1
    v_lshlrev_b32 v24, 3, v31
    v_lshl_or_b32 v24, v30, 8, v24
    v_add_u32 v24, s56, v24
    v_and_b32 v29, 7, v30
    v_xor_b32 v28, 0, v29
    v_lshl_add_u32 v12, v28, 5, v24
    v_xor_b32 v28, 1, v29
    v_lshl_add_u32 v13, v28, 5, v24
    v_xor_b32 v28, 2, v29
    v_lshl_add_u32 v14, v28, 5, v24
    v_xor_b32 v28, 3, v29
    v_lshl_add_u32 v15, v28, 5, v24
    v_xor_b32 v28, 4, v29
    v_lshl_add_u32 v16, v28, 5, v24
    v_xor_b32 v28, 5, v29
    v_lshl_add_u32 v17, v28, 5, v24
    v_xor_b32 v28, 6, v29
    v_lshl_add_u32 v18, v28, 5, v24
    v_xor_b32 v28, 7, v29
    v_lshl_add_u32 v19, v28, 5, v24
    s_lshl_b32 s58, s54, 18
    s_lshl_b32 s59, s52, 16
    s_add_u32 s58, s58, s59
    s_lshl_b32 s59, s53, 8
    s_add_u32 s96, s58, s59
    v_lshlrev_b32 v27, 2, v25
    v_xor_b32 v27, v26, v27
    v_lshlrev_b32 v27, 4, v27
    v_lshl_or_b32 v20, v25, 11, v27
    v_and_b32 v29, 3, v30
    v_lshlrev_b32 v29, 2, v29
    s_lshl_b32 s57, s52, 2
    v_add_u32 v28, s57, v31
    v_xor_b32 v28, v28, v29
    v_lshlrev_b32 v28, 4, v28
    v_lshl_or_b32 v28, v30, 8, v28
    v_add_u32 v21, 24576, v28
    v_and_b32 v28, 7, v1
    v_lshlrev_b32 v27, 4, v25
    v_lshl_or_b32 v28, v28, 8, v27
    v_add_u32 v30, 147968, v28
    v_mov_b32 v31, 154496
    s_waitcnt vmcnt(9)
    buffer_load_dwordx4 v4, s[20:23], s61 offen offset:2048 nt lds
    s_waitcnt vmcnt(9)
    buffer_load_dwordx4 v5, s[20:23], s61 offen offset:3072 nt lds
    s_waitcnt vmcnt(9)
    s_add_u32 m0, s56, 8192
    s_add_u32 s61, s98, 1048576
    buffer_load_dwordx4 v2, s[20:23], s61 offen offset:0 nt lds
    s_waitcnt vmcnt(9)
    buffer_load_dwordx4 v3, s[20:23], s61 offen offset:1024 nt lds
    s_waitcnt vmcnt(9)
    buffer_load_dwordx4 v4, s[20:23], s61 offen offset:2048 nt lds
    s_waitcnt vmcnt(5)
    buffer_load_dwordx4 v5, s[20:23], s61 offen offset:3072 nt lds
    s_waitcnt vmcnt(5)
    s_add_u32 m0, s56, 12288
    s_add_u32 s61, s98, 1081344
    buffer_load_dwordx4 v2, s[20:23], s61 offen offset:0 nt lds
    s_waitcnt vmcnt(5)
    buffer_load_dwordx4 v3, s[20:23], s61 offen offset:1024 nt lds
    ds_read_b32 v28, v31 offset:20
    ds_read_b64_tr_b16 v[224:225], v12 offset:0
    ds_read_b64_tr_b16 v[226:227], v12 offset:4096
    ds_read_b64_tr_b16 v[228:229], v13 offset:0
    ds_read_b64_tr_b16 v[230:231], v13 offset:4096
    ds_read_b64_tr_b16 v[232:233], v14 offset:0
    ds_read_b64_tr_b16 v[234:235], v14 offset:4096
    ds_read_b64_tr_b16 v[236:237], v15 offset:0
    ds_read_b64_tr_b16 v[238:239], v15 offset:4096
    ds_read_b64_tr_b16 v[240:241], v16 offset:0
    ds_read_b64_tr_b16 v[242:243], v16 offset:4096
    ds_read_b64_tr_b16 v[244:245], v17 offset:0
    ds_read_b64_tr_b16 v[246:247], v17 offset:4096
    ds_read_b64_tr_b16 v[248:249], v18 offset:0
    ds_read_b64_tr_b16 v[250:251], v18 offset:4096
    ds_read_b64_tr_b16 v[252:253], v19 offset:0
    ds_read_b64_tr_b16 v[254:255], v19 offset:4096
    s_waitcnt lgkmcnt(14)
    v_mfma_f32_16x16x32_bf16 v[128:131], v[224:227], v[32:35], 0
    s_waitcnt lgkmcnt(12)
    v_mfma_f32_16x16x32_bf16 v[132:135], v[228:231], v[32:35], 0
    s_waitcnt lgkmcnt(10)
    v_mfma_f32_16x16x32_bf16 v[136:139], v[232:235], v[32:35], 0
    s_waitcnt lgkmcnt(8)
    v_mfma_f32_16x16x32_bf16 v[140:143], v[236:239], v[32:35], 0
    s_waitcnt lgkmcnt(6)
    v_mfma_f32_16x16x32_bf16 v[144:147], v[240:243], v[32:35], 0
    s_waitcnt lgkmcnt(4)
    v_mfma_f32_16x16x32_bf16 v[148:151], v[244:247], v[32:35], 0
    s_waitcnt lgkmcnt(2)
    v_mfma_f32_16x16x32_bf16 v[152:155], v[248:251], v[32:35], 0
    s_waitcnt lgkmcnt(0)
    v_mfma_f32_16x16x32_bf16 v[156:159], v[252:255], v[32:35], 0
    v_readfirstlane_b32 s16, v28
    s_waitcnt vmcnt(5)
    buffer_load_dwordx4 v4, s[20:23], s61 offen offset:2048 nt lds
    s_waitcnt vmcnt(5)
    buffer_load_dwordx4 v5, s[20:23], s61 offen offset:3072 nt lds
    s_waitcnt vmcnt(5)
    s_add_u32 m0, s56, 0
    s_add_u32 s61, s98, 2097152
    buffer_load_dwordx4 v2, s[20:23], s61 offen offset:0 nt lds
    s_waitcnt vmcnt(5)
    buffer_load_dwordx4 v3, s[20:23], s61 offen offset:1024 nt lds
    s_waitcnt vmcnt(5)
    buffer_load_dwordx4 v4, s[20:23], s61 offen offset:2048 nt lds
    s_waitcnt vmcnt(5)
    buffer_load_dwordx4 v5, s[20:23], s61 offen offset:3072 nt lds
    s_waitcnt vmcnt(5)
    s_add_u32 m0, s56, 4096
    s_add_u32 s61, s98, 2129920
    buffer_load_dwordx4 v2, s[20:23], s61 offen offset:0 nt lds
    s_waitcnt vmcnt(5)
    buffer_load_dwordx4 v3, s[20:23], s61 offen offset:1024 nt lds
    ds_read_b32 v28, v31 offset:20
    ds_read_b64_tr_b16 v[224:225], v12 offset:8192
    ds_read_b64_tr_b16 v[226:227], v12 offset:12288
    ds_read_b64_tr_b16 v[228:229], v13 offset:8192
    ds_read_b64_tr_b16 v[230:231], v13 offset:12288
    ds_read_b64_tr_b16 v[232:233], v14 offset:8192
    ds_read_b64_tr_b16 v[234:235], v14 offset:12288
    ds_read_b64_tr_b16 v[236:237], v15 offset:8192
    ds_read_b64_tr_b16 v[238:239], v15 offset:12288
    ds_read_b64_tr_b16 v[240:241], v16 offset:8192
    ds_read_b64_tr_b16 v[242:243], v16 offset:12288
    ds_read_b64_tr_b16 v[244:245], v17 offset:8192
    ds_read_b64_tr_b16 v[246:247], v17 offset:12288
    ds_read_b64_tr_b16 v[248:249], v18 offset:8192
    ds_read_b64_tr_b16 v[250:251], v18 offset:12288
    ds_read_b64_tr_b16 v[252:253], v19 offset:8192
    ds_read_b64_tr_b16 v[254:255], v19 offset:12288
    s_waitcnt lgkmcnt(14)
    v_mfma_f32_16x16x32_bf16 v[128:131], v[224:227], v[36:39], v[128:131]
    s_waitcnt lgkmcnt(12)
    v_mfma_f32_16x16x32_bf16 v[132:135], v[228:231], v[36:39], v[132:135]
    s_waitcnt lgkmcnt(10)
    v_mfma_f32_16x16x32_bf16 v[136:139], v[232:235], v[36:39], v[136:139]
    s_waitcnt lgkmcnt(8)
    v_mfma_f32_16x16x32_bf16 v[140:143], v[236:239], v[36:39], v[140:143]
    s_waitcnt lgkmcnt(6)
    v_mfma_f32_16x16x32_bf16 v[144:147], v[240:243], v[36:39], v[144:147]
    s_waitcnt lgkmcnt(4)
    v_mfma_f32_16x16x32_bf16 v[148:151], v[244:247], v[36:39], v[148:151]
    s_waitcnt lgkmcnt(2)
    v_mfma_f32_16x16x32_bf16 v[152:155], v[248:251], v[36:39], v[152:155]
    s_waitcnt lgkmcnt(0)
    v_mfma_f32_16x16x32_bf16 v[156:159], v[252:255], v[36:39], v[156:159]
    v_readfirstlane_b32 s16, v28
    s_waitcnt vmcnt(5)
    buffer_load_dwordx4 v4, s[20:23], s61 offen offset:2048 nt lds
    s_waitcnt vmcnt(5)
    buffer_load_dwordx4 v5, s[20:23], s61 offen offset:3072 nt lds
    s_cmp_ge_u32 s16, 1
    s_cbranch_scc1 L_sq24
    s_waitcnt vmcnt(5)
L_sq24:
    s_add_u32 m0, s56, 8192
    s_add_u32 s61, s98, 3145728
    buffer_load_dwordx4 v2, s[20:23], s61 offen offset:0 nt lds
    s_cmp_ge_u32 s16, 2
    s_cbranch_scc1 L_sq25
    s_waitcnt vmcnt(6)
    s_cmp_ge_u32 s16, 1
    s_cbranch_scc1 L_sq25
    s_waitcnt vmcnt(5)
L_sq25:
    buffer_load_dwordx4 v3, s[20:23], s61 offen offset:1024 nt lds
    s_waitcnt vmcnt(7)
    s_cmp_ge_u32 s16, 2
    s_cbranch_scc1 L_sq26
    s_waitcnt vmcnt(6)
    s_cmp_ge_u32 s16, 1
    s_cbranch_scc1 L_sq26
    s_waitcnt vmcnt(5)
L_sq26:
    buffer_load_dwordx4 v4, s[20:23], s61 offen offset:2048 nt lds
    s_waitcnt vmcnt(7)
    s_cmp_ge_u32 s16, 2
    s_cbranch_scc1 L_sq27
    s_waitcnt vmcnt(6)
    s_cmp_ge_u32 s16, 1
    s_cbranch_scc1 L_sq27
    s_waitcnt vmcnt(5)
L_sq27:
    buffer_load_dwordx4 v5, s[20:23], s61 offen offset:3072 nt lds
    s_waitcnt vmcnt(7)
    s_cmp_ge_u32 s16, 2
    s_cbranch_scc1 L_sq28
    s_waitcnt vmcnt(6)
    s_cmp_ge_u32 s16, 1
    s_cbranch_scc1 L_sq28
    s_waitcnt vmcnt(5)
L_sq28:
    s_add_u32 m0, s56, 12288
    s_add_u32 s61, s98, 3178496
    buffer_load_dwordx4 v2, s[20:23], s61 offen offset:0 nt lds
    s_waitcnt vmcnt(7)
    s_cmp_ge_u32 s16, 2
    s_cbranch_scc1 L_sq29
    s_waitcnt vmcnt(6)
    s_cmp_ge_u32 s16, 1
    s_cbranch_scc1 L_sq29
    s_waitcnt vmcnt(5)
L_sq29:
    buffer_load_dwordx4 v3, s[20:23], s61 offen offset:1024 nt lds
    s_waitcnt vmcnt(7)
    s_cmp_ge_u32 s16, 2
    s_cbranch_scc1 L_sq30
    s_waitcnt vmcnt(6)
    s_cmp_ge_u32 s16, 1
    s_cbranch_scc1 L_sq30
    s_waitcnt vmcnt(5)
L_sq30:
    buffer_load_dwordx4 v4, s[20:23], s61 offen offset:2048 nt lds
    s_waitcnt vmcnt(7)
    s_cmp_ge_u32 s16, 2
    s_cbranch_scc1 L_sq31
    s_waitcnt vmcnt(6)
    s_cmp_ge_u32 s16, 1
    s_cbranch_scc1 L_sq31
    s_waitcnt vmcnt(5)
L_sq31:
    buffer_load_dwordx4 v5, s[20:23], s61 offen offset:3072 nt lds
    ds_read_b32 v28, v31 offset:20
    ds_read_b64_tr_b16 v[224:225], v12 offset:0
    ds_read_b64_tr_b16 v[226:227], v12 offset:4096
    ds_read_b64_tr_b16 v[228:229], v13 offset:0
    ds_read_b64_tr_b16 v[230:231], v13 offset:4096
    ds_read_b64_tr_b16 v[232:233], v14 offset:0
    ds_read_b64_tr_b16 v[234:235], v14 offset:4096
    ds_read_b64_tr_b16 v[236:237], v15 offset:0
    ds_read_b64_tr_b16 v[238:239], v15 offset:4096
    ds_read_b64_tr_b16 v[240:241], v16 offset:0
    ds_read_b64_tr_b16 v[242:243], v16 offset:4096
    ds_read_b64_tr_b16 v[244:245], v17 offset:0
    ds_read_b64_tr_b16 v[246:247], v17 offset:4096
    ds_read_b64_tr_b16 v[248:249], v18 offset:0
    ds_read_b64_tr_b16 v[250:251], v18 offset:4096
    ds_read_b64_tr_b16 v[252:253], v19 offset:0
    ds_read_b64_tr_b16 v[254:255], v19 offset:4096
    s_waitcnt lgkmcnt(14)
    v_mfma_f32_16x16x32_bf16 v[128:131], v[224:227], v[40:43], v[128:131]
    s_waitcnt lgkmcnt(12)
    v_mfma_f32_16x16x32_bf16 v[132:135], v[228:231], v[40:43], v[132:135]
    s_waitcnt lgkmcnt(10)
    v_mfma_f32_16x16x32_bf16 v[136:139], v[232:235], v[40:43], v[136:139]
    s_waitcnt lgkmcnt(8)
    v_mfma_f32_16x16x32_bf16 v[140:143], v[236:239], v[40:43], v[140:143]
    s_waitcnt lgkmcnt(6)
    v_mfma_f32_16x16x32_bf16 v[144:147], v[240:243], v[40:43], v[144:147]
    s_waitcnt lgkmcnt(4)
    v_mfma_f32_16x16x32_bf16 v[148:151], v[244:247], v[40:43], v[148:151]
    s_waitcnt lgkmcnt(2)
    v_mfma_f32_16x16x32_bf16 v[152:155], v[248:251], v[40:43], v[152:155]
    s_waitcnt lgkmcnt(0)
    v_mfma_f32_16x16x32_bf16 v[156:159], v[252:255], v[40:43], v[156:159]
    v_readfirstlane_b32 s16, v28
    s_waitcnt vmcnt(6)
    s_cmp_ge_u32 s16, 2
    s_cbranch_scc1 L_sq32
    s_waitcnt vmcnt(5)
    s_cmp_ge_u32 s16, 1
    s_cbranch_scc1 L_sq32
    s_waitcnt vmcnt(4)
L_sq32:
    v_add_u32 v29, 0, v25
    v_xor_b32 v29, v26, v29
    v_lshlrev_b32 v29, 4, v29
    v_lshl_or_b32 v2, v25, 8, v29
    v_add_u32 v29, 4, v25
    v_xor_b32 v29, v26, v29
    v_lshlrev_b32 v29, 4, v29
    v_lshl_or_b32 v3, v25, 8, v29
    v_add_u32 v29, 8, v25
    v_xor_b32 v29, v26, v29
    v_lshlrev_b32 v29, 4, v29
    v_lshl_or_b32 v4, v25, 8, v29
    v_add_u32 v29, 12, v25
    v_xor_b32 v29, v26, v29
    v_lshlrev_b32 v29, 4, v29
    v_lshl_or_b32 v5, v25, 8, v29
    s_add_u32 m0, s56, 0
    s_add_u32 s61, s55, 0
    buffer_load_dwordx4 v2, s[28:31], s61 offen offset:0 nt lds
    v_mov_b32 v29, 1
    s_mov_b64 exec, 1
    ds_add_u32 v31, v29 offset:8
    s_mov_b64 exec, -1
    s_waitcnt vmcnt(6)
    s_cmp_ge_u32 s16, 2
    s_cbranch_scc1 L_sq33
    s_waitcnt vmcnt(5)
    s_cmp_ge_u32 s16, 1
    s_cbranch_scc1 L_sq33
    s_waitcnt vmcnt(4)
L_sq33:
    buffer_load_dwordx4 v3, s[28:31], s61 offen offset:1024 nt lds
    s_waitcnt vmcnt(6)
    s_cmp_ge_u32 s16, 2
    s_cbranch_scc1 L_sq34
    s_waitcnt vmcnt(5)
    s_cmp_ge_u32 s16, 1
    s_cbranch_scc1 L_sq34
    s_waitcnt vmcnt(4)
L_sq34:
    buffer_load_dwordx4 v4, s[28:31], s61 offen offset:2048 nt lds
    s_waitcnt vmcnt(6)
    s_cmp_ge_u32 s16, 2
    s_cbranch_scc1 L_sq35
    s_waitcnt vmcnt(5)
    s_cmp_ge_u32 s16, 1
    s_cbranch_scc1 L_sq35
    s_waitcnt vmcnt(4)
L_sq35:
    buffer_load_dwordx4 v5, s[28:31], s61 offen offset:3072 nt lds
    s_waitcnt vmcnt(6)
    s_cmp_ge_u32 s16, 2
    s_cbranch_scc1 L_sq36
    s_waitcnt vmcnt(5)
    s_cmp_ge_u32 s16, 1
    s_cbranch_scc1 L_sq36
    s_waitcnt vmcnt(4)
L_sq36:
    s_add_u32 m0, s56, 4096
    s_add_u32 s61, s55, 4096
    buffer_load_dwordx4 v2, s[28:31], s61 offen offset:0 nt lds
    s_waitcnt vmcnt(6)
    s_cmp_ge_u32 s16, 2
    s_cbranch_scc1 L_sq37
    s_waitcnt vmcnt(5)
    s_cmp_ge_u32 s16, 1
    s_cbranch_scc1 L_sq37
    s_waitcnt vmcnt(4)
L_sq37:
    buffer_load_dwordx4 v3, s[28:31], s61 offen offset:1024 nt lds
    s_waitcnt vmcnt(6)
    s_cmp_ge_u32 s16, 2
    s_cbranch_scc1 L_sq38
    s_waitcnt vmcnt(5)
    s_cmp_ge_u32 s16, 1
    s_cbranch_scc1 L_sq38
    s_waitcnt vmcnt(4)
L_sq38:
    buffer_load_dwordx4 v4, s[28:31], s61 offen offset:2048 nt lds
    ds_read_b32 v28, v31 offset:20
    ds_read_b64_tr_b16 v[224:225], v12 offset:8192
    ds_read_b64_tr_b16 v[226:227], v12 offset:12288
    ds_read_b64_tr_b16 v[228:229], v13 offset:8192
    ds_read_b64_tr_b16 v[230:231], v13 offset:12288
    ds_read_b64_tr_b16 v[232:233], v14 offset:8192
    ds_read_b64_tr_b16 v[234:235], v14 offset:12288
    ds_read_b64_tr_b16 v[236:237], v15 offset:8192
    ds_read_b64_tr_b16 v[238:239], v15 offset:12288
    ds_read_b64_tr_b16 v[240:241], v16 offset:8192
    ds_read_b64_tr_b16 v[242:243], v16 offset:12288
    ds_read_b64_tr_b16 v[244:245], v17 offset:8192
    ds_read_b64_tr_b16 v[246:247], v17 offset:12288
    ds_read_b64_tr_b16 v[248:249], v18 offset:8192
    ds_read_b64_tr_b16 v[250:251], v18 offset:12288
    ds_read_b64_tr_b16 v[252:253], v19 offset:8192
    ds_read_b64_tr_b16 v[254:255], v19 offset:12288
    s_waitcnt lgkmcnt(14)
    v_mfma_f32_16x16x32_bf16 v[128:131], v[224:227], v[44:47], v[128:131]
    s_waitcnt lgkmcnt(12)
    v_mfma_f32_16x16x32_bf16 v[132:135], v[228:231], v[44:47], v[132:135]
    s_waitcnt lgkmcnt(10)
    v_mfma_f32_16x16x32_bf16 v[136:139], v[232:235], v[44:47], v[136:139]
    s_waitcnt lgkmcnt(8)
    v_mfma_f32_16x16x32_bf16 v[140:143], v[236:239], v[44:47], v[140:143]
    s_waitcnt lgkmcnt(6)
    v_mfma_f32_16x16x32_bf16 v[144:147], v[240:243], v[44:47], v[144:147]
    s_waitcnt lgkmcnt(4)
    v_mfma_f32_16x16x32_bf16 v[148:151], v[244:247], v[44:47], v[148:151]
    s_waitcnt lgkmcnt(2)
    v_mfma_f32_16x16x32_bf16 v[152:155], v[248:251], v[44:47], v[152:155]
    s_waitcnt lgkmcnt(0)
    v_mfma_f32_16x16x32_bf16 v[156:159], v[252:255], v[44:47], v[156:159]
    v_readfirstlane_b32 s16, v28
    s_nop 1
    ds_write_b128 v48, v[128:131] offset:0
    ds_write_b128 v49, v[132:135] offset:0
    ds_write_b128 v48, v[136:139] offset:128
    ds_write_b128 v49, v[140:143] offset:128
    ds_write_b128 v48, v[144:147] offset:256
    ds_write_b128 v49, v[148:151] offset:256
    ds_write_b128 v48, v[152:155] offset:384
    s_nop 1
    ds_write_b128 v49, v[156:159] offset:384
    v_mov_b32 v29, 1
    s_mov_b64 exec, 1
    ds_add_u32 v31, v29 offset:4
    s_mov_b64 exec, -1
    s_waitcnt lgkmcnt(0)
    s_waitcnt vmcnt(6)
    s_cmp_ge_u32 s16, 2
    s_cbranch_scc1 L_sq39
    s_waitcnt vmcnt(5)
    s_cmp_ge_u32 s16, 1
    s_cbranch_scc1 L_sq39
    s_waitcnt vmcnt(4)
L_sq39:
    buffer_load_dwordx4 v5, s[28:31], s61 offen offset:3072 nt lds
    s_waitcnt vmcnt(6)
    s_cmp_ge_u32 s16, 2
    s_cbranch_scc1 L_sq40
    s_waitcnt vmcnt(5)
    s_cmp_ge_u32 s16, 1
    s_cbranch_scc1 L_sq40
    s_waitcnt vmcnt(4)
L_sq40:
    s_add_u32 m0, s56, 8192
    s_add_u32 s61, s55, 32768
    buffer_load_dwordx4 v2, s[28:31], s61 offen offset:0 nt lds
    s_waitcnt vmcnt(6)
    s_cmp_ge_u32 s16, 2
    s_cbranch_scc1 L_sq41
    s_waitcnt vmcnt(5)
    s_cmp_ge_u32 s16, 1
    s_cbranch_scc1 L_sq41
    s_waitcnt vmcnt(4)
L_sq41:
    buffer_load_dwordx4 v3, s[28:31], s61 offen offset:1024 nt lds
    s_waitcnt vmcnt(6)
    s_cmp_ge_u32 s16, 2
    s_cbranch_scc1 L_sq42
    s_waitcnt vmcnt(5)
    s_cmp_ge_u32 s16, 1
    s_cbranch_scc1 L_sq42
    s_waitcnt vmcnt(4)
L_sq42:
    buffer_load_dwordx4 v4, s[28:31], s61 offen offset:2048 nt lds
    s_waitcnt vmcnt(6)
    s_cmp_ge_u32 s16, 2
    s_cbranch_scc1 L_sq43
    s_waitcnt vmcnt(5)
    s_cmp_ge_u32 s16, 1
    s_cbranch_scc1 L_sq43
    s_waitcnt vmcnt(4)
L_sq43:
    buffer_load_dwordx4 v5, s[28:31], s61 offen offset:3072 nt lds
    s_waitcnt vmcnt(6)
    s_cmp_ge_u32 s16, 2
    s_cbranch_scc1 L_sq44
    s_waitcnt vmcnt(5)
    s_cmp_ge_u32 s16, 1
    s_cbranch_scc1 L_sq44
    s_waitcnt vmcnt(4)
L_sq44:
    s_add_u32 m0, s56, 12288
    s_add_u32 s61, s55, 36864
    buffer_load_dwordx4 v2, s[28:31], s61 offen offset:0 nt lds
    s_waitcnt vmcnt(6)
    s_cmp_ge_u32 s16, 2
    s_cbranch_scc1 L_sq45
    s_waitcnt vmcnt(5)
    s_cmp_ge_u32 s16, 1
    s_cbranch_scc1 L_sq45
    s_waitcnt vmcnt(4)
L_sq45:
    buffer_load_dwordx4 v3, s[28:31], s61 offen offset:1024 nt lds
    s_waitcnt vmcnt(6)
    s_cmp_ge_u32 s16, 2
    s_cbranch_scc1 L_sq46
    s_waitcnt vmcnt(5)
    s_cmp_ge_u32 s16, 1
    s_cbranch_scc1 L_sq46
    s_waitcnt vmcnt(4)
L_sq46:
    buffer_load_dwordx4 v4, s[28:31], s61 offen offset:2048 nt lds
    ds_read_b32 v28, v31 offset:20
    ds_read_b128 v[64:67], v8 offset:0
    ds_read_b128 v[68:71], v9 offset:0
    ds_read_b128 v[72:75], v10 offset:0
    ds_read_b128 v[76:79], v11 offset:0
    ds_read_b128 v[80:83], v8 offset:4096
    ds_read_b128 v[84:87], v9 offset:4096
    ds_read_b128 v[88:91], v10 offset:4096
    ds_read_b128 v[92:95], v11 offset:4096
    s_waitcnt lgkmcnt(0)
    v_readfirstlane_b32 s16, v28
    s_waitcnt vmcnt(6)
    s_cmp_ge_u32 s16, 2
    s_cbranch_scc1 L_sq47
    s_waitcnt vmcnt(5)
    s_cmp_ge_u32 s16, 1
    s_cbranch_scc1 L_sq47
    s_waitcnt vmcnt(4)
L_sq47:
    buffer_load_dwordx4 v5, s[28:31], s61 offen offset:3072 nt lds
    s_waitcnt vmcnt(6)
    s_cmp_ge_u32 s16, 2
    s_cbranch_scc1 L_sq48
    s_waitcnt vmcnt(5)
    s_cmp_ge_u32 s16, 1
    s_cbranch_scc1 L_sq48
    s_waitcnt vmcnt(4)
L_sq48:
    s_add_u32 m0, s56, 0
    s_add_u32 s61, s55, 65536
    buffer_load_dwordx4 v2, s[28:31], s61 offen offset:0 nt lds
    s_waitcnt vmcnt(6)
    s_cmp_ge_u32 s16, 2
    s_cbranch_scc1 L_sq49
    s_waitcnt vmcnt(5)
    s_cmp_ge_u32 s16, 1
    s_cbranch_scc1 L_sq49
    s_waitcnt vmcnt(4)
L_sq49:
    buffer_load_dwordx4 v3, s[28:31], s61 offen offset:1024 nt lds
    s_waitcnt vmcnt(6)
    s_cmp_ge_u32 s16, 2
    s_cbranch_scc1 L_sq50
    s_waitcnt vmcnt(5)
    s_cmp_ge_u32 s16, 1
    s_cbranch_scc1 L_sq50
    s_waitcnt vmcnt(4)
L_sq50:
    buffer_load_dwordx4 v4, s[28:31], s61 offen offset:2048 nt lds
    s_waitcnt vmcnt(6)
    s_cmp_ge_u32 s16, 2
    s_cbranch_scc1 L_sq51
    s_waitcnt vmcnt(5)
    s_cmp_ge_u32 s16, 1
    s_cbranch_scc1 L_sq51
    s_waitcnt vmcnt(4)
L_sq51:
    buffer_load_dwordx4 v5, s[28:31], s61 offen offset:3072 nt lds
    s_waitcnt vmcnt(6)
    s_cmp_ge_u32 s16, 2
    s_cbranch_scc1 L_sq52
    s_waitcnt vmcnt(5)
    s_cmp_ge_u32 s16, 1
    s_cbranch_scc1 L_sq52
    s_waitcnt vmcnt(4)
L_sq52:
    s_add_u32 m0, s56, 4096
    s_add_u32 s61, s55, 69632
    buffer_load_dwordx4 v2, s[28:31], s61 offen offset:0 nt lds
    s_waitcnt vmcnt(6)
    s_cmp_ge_u32 s16, 2
    s_cbranch_scc1 L_sq53
    s_waitcnt vmcnt(5)
    s_cmp_ge_u32 s16, 1
    s_cbranch_scc1 L_sq53
    s_waitcnt vmcnt(4)
L_sq53:
    buffer_load_dwordx4 v3, s[28:31], s61 offen offset:1024 nt lds
    s_waitcnt vmcnt(6)
    s_cmp_ge_u32 s16, 2
    s_cbranch_scc1 L_sq54
    s_waitcnt vmcnt(5)
    s_cmp_ge_u32 s16, 1
    s_cbranch_scc1 L_sq54
    s_waitcnt vmcnt(4)
L_sq54:
    buffer_load_dwordx4 v4, s[28:31], s61 offen offset:2048 nt lds
    ds_read_b32 v28, v31 offset:20
    ds_read_b128 v[96:99], v8 offset:8192
    ds_read_b128 v[100:103], v9 offset:8192
    ds_read_b128 v[104:107], v10 offset:8192
    ds_read_b128 v[108:111], v11 offset:8192
    ds_read_b128 v[112:115], v8 offset:12288
    ds_read_b128 v[116:119], v9 offset:12288
    ds_read_b128 v[120:123], v10 offset:12288
    ds_read_b128 v[124:127], v11 offset:12288
    s_waitcnt lgkmcnt(0)
    v_readfirstlane_b32 s16, v28
    s_waitcnt vmcnt(6)
    s_cmp_ge_u32 s16, 2
    s_cbranch_scc1 L_sq55
    s_waitcnt vmcnt(5)
    s_cmp_ge_u32 s16, 1
    s_cbranch_scc1 L_sq55
    s_waitcnt vmcnt(4)
L_sq55:
    buffer_load_dwordx4 v5, s[28:31], s61 offen offset:3072 nt lds
    s_waitcnt vmcnt(6)
    s_cmp_ge_u32 s16, 2
    s_cbranch_scc1 L_sq56
    s_waitcnt vmcnt(5)
    s_cmp_ge_u32 s16, 1
    s_cbranch_scc1 L_sq56
    s_waitcnt vmcnt(4)
L_sq56:
    s_add_u32 m0, s56, 8192
    s_add_u32 s61, s55, 98304
    buffer_load_dwordx4 v2, s[28:31], s61 offen offset:0 nt lds
    v_mov_b32 v29, 1
    s_mov_b64 exec, 1
    ds_add_u32 v31, v29 offset:8
    s_mov_b64 exec, -1
    s_waitcnt vmcnt(6)
    s_cmp_ge_u32 s16, 2
    s_cbranch_scc1 L_sq57
    s_waitcnt vmcnt(5)
    s_cmp_ge_u32 s16, 1
    s_cbranch_scc1 L_sq57
    s_waitcnt vmcnt(4)
L_sq57:
    buffer_load_dwordx4 v3, s[28:31], s61 offen offset:1024 nt lds
    s_waitcnt vmcnt(6)
    s_cmp_ge_u32 s16, 2
    s_cbranch_scc1 L_sq58
    s_waitcnt vmcnt(5)
    s_cmp_ge_u32 s16, 1
    s_cbranch_scc1 L_sq58
    s_waitcnt vmcnt(4)
L_sq58:
    buffer_load_dwordx4 v4, s[28:31], s61 offen offset:2048 nt lds
    s_waitcnt vmcnt(6)
    s_cmp_ge_u32 s16, 2
    s_cbranch_scc1 L_sq59
    s_waitcnt vmcnt(5)
    s_cmp_ge_u32 s16, 1
    s_cbranch_scc1 L_sq59
    s_waitcnt vmcnt(4)
L_sq59:
    buffer_load_dwordx4 v5, s[28:31], s61 offen offset:3072 nt lds
    s_waitcnt vmcnt(6)
    s_cmp_ge_u32 s16, 2
    s_cbranch_scc1 L_sq60
    s_waitcnt vmcnt(5)
    s_cmp_ge_u32 s16, 1
    s_cbranch_scc1 L_sq60
    s_waitcnt vmcnt(4)
L_sq60:
    s_add_u32 m0, s56, 12288
    s_add_u32 s61, s55, 102400
    buffer_load_dwordx4 v2, s[28:31], s61 offen offset:0 nt lds
    s_waitcnt vmcnt(6)
    s_cmp_ge_u32 s16, 2
    s_cbranch_scc1 L_sq61
    s_waitcnt vmcnt(5)
    s_cmp_ge_u32 s16, 1
    s_cbranch_scc1 L_sq61
    s_waitcnt vmcnt(4)
L_sq61:
    buffer_load_dwordx4 v3, s[28:31], s61 offen offset:1024 nt lds
    s_waitcnt vmcnt(6)
    s_cmp_ge_u32 s16, 2
    s_cbranch_scc1 L_sq62
    s_waitcnt vmcnt(5)
    s_cmp_ge_u32 s16, 1
    s_cbranch_scc1 L_sq62
    s_waitcnt vmcnt(4)
L_sq62:
    buffer_load_dwordx4 v4, s[28:31], s61 offen offset:2048 nt lds
    ds_read_b32 v28, v31 offset:20
    ds_read_b128 v[128:131], v8 offset:0
    ds_read_b128 v[132:135], v9 offset:0
    ds_read_b128 v[136:139], v10 offset:0
    ds_read_b128 v[140:143], v11 offset:0
    ds_read_b128 v[144:147], v8 offset:4096
    ds_read_b128 v[148:151], v9 offset:4096
    ds_read_b128 v[152:155], v10 offset:4096
    ds_read_b128 v[156:159], v11 offset:4096
    s_waitcnt lgkmcnt(0)
    v_readfirstlane_b32 s16, v28
    s_waitcnt vmcnt(6)
    s_cmp_ge_u32 s16, 2
    s_cbranch_scc1 L_sq63
    s_waitcnt vmcnt(5)
    s_cmp_ge_u32 s16, 1
    s_cbranch_scc1 L_sq63
    s_waitcnt vmcnt(4)
L_sq63:
    buffer_load_dwordx4 v5, s[28:31], s61 offen offset:3072 nt lds
    s_waitcnt vmcnt(6)
    s_cmp_ge_u32 s16, 2
    s_cbranch_scc1 L_sq64
    s_waitcnt vmcnt(5)
    s_cmp_ge_u32 s16, 1
    s_cbranch_scc1 L_sq64
    s_waitcnt vmcnt(4)
L_sq64:
    s_add_u32 m0, s56, 0
    s_add_u32 s61, s55, 131072
    buffer_load_dwordx4 v2, s[28:31], s61 offen offset:0 nt lds
    s_waitcnt vmcnt(6)
    s_cmp_ge_u32 s16, 2
    s_cbranch_scc1 L_sq65
    s_waitcnt vmcnt(5)
    s_cmp_ge_u32 s16, 1
    s_cbranch_scc1 L_sq65
    s_waitcnt vmcnt(4)
L_sq65:
    buffer_load_dwordx4 v3, s[28:31], s61 offen offset:1024 nt lds
    s_waitcnt vmcnt(6)
    s_cmp_ge_u32 s16, 2
    s_cbranch_scc1 L_sq66
    s_waitcnt vmcnt(5)
    s_cmp_ge_u32 s16, 1
    s_cbranch_scc1 L_sq66
    s_waitcnt vmcnt(4)
L_sq66:
    buffer_load_dwordx4 v4, s[28:31], s61 offen offset:2048 nt lds
    s_waitcnt vmcnt(6)
    s_cmp_ge_u32 s16, 2
    s_cbranch_scc1 L_sq67
    s_waitcnt vmcnt(5)
    s_cmp_ge_u32 s16, 1
    s_cbranch_scc1 L_sq67
    s_waitcnt vmcnt(4)
L_sq67:
    buffer_load_dwordx4 v5, s[28:31], s61 offen offset:3072 nt lds
    s_waitcnt vmcnt(6)
    s_cmp_ge_u32 s16, 2
    s_cbranch_scc1 L_sq68
    s_waitcnt vmcnt(5)
    s_cmp_ge_u32 s16, 1
    s_cbranch_scc1 L_sq68
    s_waitcnt vmcnt(4)
L_sq68:
    s_add_u32 m0, s56, 4096
    s_add_u32 s61, s55, 135168
    buffer_load_dwordx4 v2, s[28:31], s61 offen offset:0 nt lds
    s_waitcnt vmcnt(6)
    s_cmp_ge_u32 s16, 2
    s_cbranch_scc1 L_sq69
    s_waitcnt vmcnt(5)
    s_cmp_ge_u32 s16, 1
    s_cbranch_scc1 L_sq69
    s_waitcnt vmcnt(4)
L_sq69:
    buffer_load_dwordx4 v3, s[28:31], s61 offen offset:1024 nt lds
    s_waitcnt vmcnt(6)
    s_cmp_ge_u32 s16, 2
    s_cbranch_scc1 L_sq70
    s_waitcnt vmcnt(5)
    s_cmp_ge_u32 s16, 1
    s_cbranch_scc1 L_sq70
    s_waitcnt vmcnt(4)
L_sq70:
    buffer_load_dwordx4 v4, s[28:31], s61 offen offset:2048 nt lds
    ds_read_b32 v28, v31 offset:20
    ds_read_b128 v[160:163], v8 offset:8192
    ds_read_b128 v[164:167], v9 offset:8192
    ds_read_b128 v[168:171], v10 offset:8192
    ds_read_b128 v[172:175], v11 offset:8192
    ds_read_b128 v[176:179], v8 offset:12288
    ds_read_b128 v[180:183], v9 offset:12288
    ds_read_b128 v[184:187], v10 offset:12288
    ds_read_b128 v[188:191], v11 offset:12288
    s_waitcnt lgkmcnt(0)
    v_readfirstlane_b32 s16, v28
    s_waitcnt vmcnt(6)
    s_cmp_ge_u32 s16, 2
    s_cbranch_scc1 L_sq71
    s_waitcnt vmcnt(5)
    s_cmp_ge_u32 s16, 1
    s_cbranch_scc1 L_sq71
    s_waitcnt vmcnt(4)
L_sq71:
    buffer_load_dwordx4 v5, s[28:31], s61 offen offset:3072 nt lds
    s_waitcnt vmcnt(6)
    s_cmp_ge_u32 s16, 2
    s_cbranch_scc1 L_sq72
    s_waitcnt vmcnt(5)
    s_cmp_ge_u32 s16, 1
    s_cbranch_scc1 L_sq72
    s_waitcnt vmcnt(4)
L_sq72:
    s_add_u32 m0, s56, 8192
    s_add_u32 s61, s55, 163840
    buffer_load_dwordx4 v2, s[28:31], s61 offen offset:0 nt lds
    s_waitcnt vmcnt(6)
    s_cmp_ge_u32 s16, 2
    s_cbranch_scc1 L_sq73
    s_waitcnt vmcnt(5)
    s_cmp_ge_u32 s16, 1
    s_cbranch_scc1 L_sq73
    s_waitcnt vmcnt(4)
L_sq73:
    buffer_load_dwordx4 v3, s[28:31], s61 offen offset:1024 nt lds
    s_waitcnt vmcnt(6)
    s_cmp_ge_u32 s16, 2
    s_cbranch_scc1 L_sq74
    s_waitcnt vmcnt(5)
    s_cmp_ge_u32 s16, 1
    s_cbranch_scc1 L_sq74
    s_waitcnt vmcnt(4)
L_sq74:
    buffer_load_dwordx4 v4, s[28:31], s61 offen offset:2048 nt lds
    s_waitcnt vmcnt(6)
    s_cmp_ge_u32 s16, 2
    s_cbranch_scc1 L_sq75
    s_waitcnt vmcnt(5)
    s_cmp_ge_u32 s16, 1
    s_cbranch_scc1 L_sq75
    s_waitcnt vmcnt(4)
L_sq75:
    buffer_load_dwordx4 v5, s[28:31], s61 offen offset:3072 nt lds
    v_mov_b32 v29, 1
    s_mov_b64 exec, 1
    ds_add_u32 v31, v29 offset:8
    s_mov_b64 exec, -1
    s_waitcnt vmcnt(6)
    s_cmp_ge_u32 s16, 2
    s_cbranch_scc1 L_sq76
    s_waitcnt vmcnt(5)
    s_cmp_ge_u32 s16, 1
    s_cbranch_scc1 L_sq76
    s_waitcnt vmcnt(4)
L_sq76:
    s_add_u32 m0, s56, 12288
    s_add_u32 s61, s55, 167936
    buffer_load_dwordx4 v2, s[28:31], s61 offen offset:0 nt lds
    s_waitcnt vmcnt(6)
    s_cmp_ge_u32 s16, 2
    s_cbranch_scc1 L_sq77
    s_waitcnt vmcnt(5)
    s_cmp_ge_u32 s16, 1
    s_cbranch_scc1 L_sq77
    s_waitcnt vmcnt(4)
L_sq77:
    buffer_load_dwordx4 v3, s[28:31], s61 offen offset:1024 nt lds
    s_waitcnt vmcnt(6)
    s_cmp_ge_u32 s16, 2
    s_cbranch_scc1 L_sq78
    s_waitcnt vmcnt(5)
    s_cmp_ge_u32 s16, 1
    s_cbranch_scc1 L_sq78
    s_waitcnt vmcnt(4)
L_sq78:
    buffer_load_dwordx4 v4, s[28:31], s61 offen offset:2048 nt lds
    s_waitcnt vmcnt(6)
    s_cmp_ge_u32 s16, 2
    s_cbranch_scc1 L_sq79
    s_waitcnt vmcnt(5)
    s_cmp_ge_u32 s16, 1
    s_cbranch_scc1 L_sq79
    s_waitcnt vmcnt(4)
L_sq79:
    buffer_load_dwordx4 v5, s[28:31], s61 offen offset:3072 nt lds
L_qwq:
    ds_read_b32 v29, v31 offset:0
    s_waitcnt lgkmcnt(0)
    v_cmp_gt_u32 vcc, 1, v29
    s_and_b64 exec, exec, vcc
    s_cbranch_scc0 L_qwq_done
    s_sleep 1
    s_add_u32 s63, s63, 1
    s_cmp_lt_u32 s63, 1048576
    s_cbranch_scc1 L_qwq
L_qwq_done:
    s_mov_b64 exec, -1
    ds_read_b32 v29, v31 offset:16
    ds_read_b128 v[32:35], v30 offset:0
    ds_read_b128 v[36:39], v30 offset:64
    ds_read_b128 v[40:43], v30 offset:128
    ds_read_b128 v[44:47], v30 offset:192
    s_waitcnt lgkmcnt(0)
    v_readfirstlane_b32 s60, v29
    ds_read_b32 v28, v31 offset:20
    ds_read_b128 v[224:227], v8 offset:0
    ds_read_b128 v[228:231], v9 offset:0
    ds_read_b128 v[232:235], v10 offset:0
    ds_read_b128 v[236:239], v11 offset:0
    ds_read_b128 v[240:243], v8 offset:4096
    ds_read_b128 v[244:247], v9 offset:4096
    ds_read_b128 v[248:251], v10 offset:4096
    ds_read_b128 v[252:255], v11 offset:4096
    v_mfma_f32_16x16x32_bf16 v[48:51], v[64:67], v[32:35], 0
    v_mfma_f32_16x16x32_bf16 v[48:51], v[68:71], v[36:39], v[48:51]
    v_mfma_f32_16x16x32_bf16 v[48:51], v[72:75], v[40:43], v[48:51]
    v_mfma_f32_16x16x32_bf16 v[48:51], v[76:79], v[44:47], v[48:51]
    v_mfma_f32_16x16x32_bf16 v[52:55], v[80:83], v[32:35], 0
    v_mfma_f32_16x16x32_bf16 v[52:55], v[84:87], v[36:39], v[52:55]
    v_mfma_f32_16x16x32_bf16 v[52:55], v[88:91], v[40:43], v[52:55]
    v_mfma_f32_16x16x32_bf16 v[52:55], v[92:95], v[44:47], v[52:55]
    s_waitcnt lgkmcnt(0)
    v_readfirstlane_b32 s16, v28
    s_add_u32 m0, s56, 0
    s_add_u32 s61, s97, 196608
    buffer_load_dwordx4 v2, s[28:31], s61 offen offset:0 nt lds
    v_mfma_f32_16x16x32_bf16 v[56:59], v[224:227], v[32:35], 0
    v_mfma_f32_16x16x32_bf16 v[56:59], v[228:231], v[36:39], v[56:59]
    v_mfma_f32_16x16x32_bf16 v[56:59], v[232:235], v[40:43], v[56:59]
    v_mfma_f32_16x16x32_bf16 v[56:59], v[236:239], v[44:47], v[56:59]
    v_mfma_f32_16x16x32_bf16 v[60:63], v[240:243], v[32:35], 0
    v_mfma_f32_16x16x32_bf16 v[60:63], v[244:247], v[36:39], v[60:63]
    v_mfma_f32_16x16x32_bf16 v[60:63], v[248:251], v[40:43], v[60:63]
    v_mfma_f32_16x16x32_bf16 v[60:63], v[252:255], v[44:47], v[60:63]
    v_mfma_f32_16x16x32_bf16 v[64:67], v[96:99], v[32:35], 0
    v_mfma_f32_16x16x32_bf16 v[64:67], v[100:103], v[36:39], v[64:67]
    v_mfma_f32_16x16x32_bf16 v[64:67], v[104:107], v[40:43], v[64:67]
    v_mfma_f32_16x16x32_bf16 v[64:67], v[108:111], v[44:47], v[64:67]
    v_mfma_f32_16x16x32_bf16 v[68:71], v[112:115], v[32:35], 0
    v_mfma_f32_16x16x32_bf16 v[68:71], v[116:119], v[36:39], v[68:71]
    v_mfma_f32_16x16x32_bf16 v[68:71], v[120:123], v[40:43], v[68:71]
    v_mfma_f32_16x16x32_bf16 v[68:71], v[124:127], v[44:47], v[68:71]
    v_mfma_f32_16x16x32_bf16 v[72:75], v[128:131], v[32:35], 0
    v_mfma_f32_16x16x32_bf16 v[72:75], v[132:135], v[36:39], v[72:75]
    v_mfma_f32_16x16x32_bf16 v[72:75], v[136:139], v[40:43], v[72:75]
    v_mfma_f32_16x16x32_bf16 v[72:75], v[140:143], v[44:47], v[72:75]
    v_mfma_f32_16x16x32_bf16 v[76:79], v[144:147], v[32:35], 0
    v_mfma_f32_16x16x32_bf16 v[76:79], v[148:151], v[36:39], v[76:79]
    v_mfma_f32_16x16x32_bf16 v[76:79], v[152:155], v[40:43], v[76:79]
    v_mfma_f32_16x16x32_bf16 v[76:79], v[156:159], v[44:47], v[76:79]
    buffer_load_dwordx4 v3, s[28:31], s61 offen offset:1024 nt lds
    v_mfma_f32_16x16x32_bf16 v[80:83], v[160:163], v[32:35], 0
    v_mfma_f32_16x16x32_bf16 v[80:83], v[164:167], v[36:39], v[80:83]
    v_mfma_f32_16x16x32_bf16 v[80:83], v[168:171], v[40:43], v[80:83]
    v_mfma_f32_16x16x32_bf16 v[80:83], v[172:175], v[44:47], v[80:83]
    v_mfma_f32_16x16x32_bf16 v[84:87], v[176:179], v[32:35], 0
    v_mfma_f32_16x16x32_bf16 v[84:87], v[180:183], v[36:39], v[84:87]
    v_mfma_f32_16x16x32_bf16 v[84:87], v[184:187], v[40:43], v[84:87]
    v_mfma_f32_16x16x32_bf16 v[84:87], v[188:191], v[44:47], v[84:87]
    s_waitcnt vmcnt(6)
    s_cmp_ge_u32 s16, 2
    s_cbranch_scc1 L_sq82
    s_waitcnt vmcnt(5)
    s_cmp_ge_u32 s16, 1
    s_cbranch_scc1 L_sq82
    s_waitcnt vmcnt(4)
L_sq82:
    buffer_load_dwordx4 v4, s[28:31], s61 offen offset:2048 nt lds
    s_waitcnt vmcnt(6)
    s_cmp_ge_u32 s16, 2
    s_cbranch_scc1 L_sq83
    s_waitcnt vmcnt(5)
    s_cmp_ge_u32 s16, 1
    s_cbranch_scc1 L_sq83
    s_waitcnt vmcnt(4)
L_sq83:
    buffer_load_dwordx4 v5, s[28:31], s61 offen offset:3072 nt lds
    s_waitcnt vmcnt(6)
    s_cmp_ge_u32 s16, 2
    s_cbranch_scc1 L_sq84
    s_waitcnt vmcnt(5)
    s_cmp_ge_u32 s16, 1
    s_cbranch_scc1 L_sq84
    s_waitcnt vmcnt(4)
L_sq84:
    s_add_u32 m0, s56, 4096
    s_add_u32 s61, s55, 0
    buffer_load_dwordx4 v6, s[24:27], s61 offen offset:0 nt lds
    s_waitcnt vmcnt(6)
    s_cmp_ge_u32 s16, 2
    s_cbranch_scc1 L_sq85
    s_waitcnt vmcnt(5)
    s_cmp_ge_u32 s16, 1
    s_cbranch_scc1 L_sq85
    s_waitcnt vmcnt(4)
L_sq85:
    buffer_load_dwordx4 v7, s[24:27], s61 offen offset:1024 nt lds
    s_waitcnt vmcnt(6)
    s_cmp_ge_u32 s16, 2
    s_cbranch_scc1 L_sq86
    s_waitcnt vmcnt(5)
    s_cmp_ge_u32 s16, 1
    s_cbranch_scc1 L_sq86
    s_waitcnt vmcnt(4)
L_sq86:
    buffer_load_dwordx4 v6, s[24:27], s61 offen offset:2048 nt lds
    ds_read_b32 v28, v31 offset:20
    ds_read_b128 v[224:227], v8 offset:8192
    ds_read_b128 v[228:231], v9 offset:8192
    ds_read_b128 v[232:235], v10 offset:8192
    ds_read_b128 v[236:239], v11 offset:8192
    ds_read_b128 v[240:243], v8 offset:12288
    ds_read_b128 v[244:247], v9 offset:12288
    ds_read_b128 v[248:251], v10 offset:12288
    ds_read_b128 v[252:255], v11 offset:12288
    s_waitcnt lgkmcnt(0)
    v_readfirstlane_b32 s16, v28
    buffer_load_dwordx4 v7, s[24:27], s61 offen offset:3072 nt lds
    v_mfma_f32_16x16x32_bf16 v[88:91], v[224:227], v[32:35], 0
    v_mfma_f32_16x16x32_bf16 v[88:91], v[228:231], v[36:39], v[88:91]
    v_mfma_f32_16x16x32_bf16 v[88:91], v[232:235], v[40:43], v[88:91]
    v_mfma_f32_16x16x32_bf16 v[88:91], v[236:239], v[44:47], v[88:91]
    v_mfma_f32_16x16x32_bf16 v[92:95], v[240:243], v[32:35], 0
    v_mfma_f32_16x16x32_bf16 v[92:95], v[244:247], v[36:39], v[92:95]
    v_mfma_f32_16x16x32_bf16 v[92:95], v[248:251], v[40:43], v[92:95]
    v_mfma_f32_16x16x32_bf16 v[92:95], v[252:255], v[44:47], v[92:95]
    s_waitcnt vmcnt(6)
    s_cmp_ge_u32 s16, 2
    s_cbranch_scc1 L_sq88
    s_waitcnt vmcnt(5)
    s_cmp_ge_u32 s16, 1
    s_cbranch_scc1 L_sq88
    s_waitcnt vmcnt(4)
L_sq88:
    s_add_u32 m0, s56, 8192
    s_add_u32 s61, s55, 4096
    buffer_load_dwordx4 v6, s[24:27], s61 offen offset:0 nt lds
    s_waitcnt vmcnt(6)
    s_cmp_ge_u32 s16, 2
    s_cbranch_scc1 L_sq89
    s_waitcnt vmcnt(5)
    s_cmp_ge_u32 s16, 1
    s_cbranch_scc1 L_sq89
    s_waitcnt vmcnt(4)
L_sq89:
    buffer_load_dwordx4 v7, s[24:27], s61 offen offset:1024 nt lds
    s_waitcnt vmcnt(6)
    s_cmp_ge_u32 s16, 2
    s_cbranch_scc1 L_sq90
    s_waitcnt vmcnt(5)
    s_cmp_ge_u32 s16, 1
    s_cbranch_scc1 L_sq90
    s_waitcnt vmcnt(4)
L_sq90:
    buffer_load_dwordx4 v6, s[24:27], s61 offen offset:2048 nt lds
    ds_read_b32 v28, v31 offset:20
    ds_read_b128 v[224:227], v8 offset:0
    ds_read_b128 v[228:231], v9 offset:0
    ds_read_b128 v[232:235], v10 offset:0
    ds_read_b128 v[236:239], v11 offset:0
    s_waitcnt lgkmcnt(0)
    v_readfirstlane_b32 s16, v28
    buffer_load_dwordx4 v7, s[24:27], s61 offen offset:3072 nt lds
    v_mfma_f32_16x16x32_bf16 v[96:99], v[224:227], v[32:35], 0
    v_mfma_f32_16x16x32_bf16 v[96:99], v[228:231], v[36:39], v[96:99]
    v_mfma_f32_16x16x32_bf16 v[96:99], v[232:235], v[40:43], v[96:99]
    v_mfma_f32_16x16x32_bf16 v[96:99], v[236:239], v[44:47], v[96:99]
    s_nop 7
    v_max3_f32 v22, v48, v49, v50
    v_max3_f32 v23, v51, v52, v53
    v_max3_f32 v24, v54, v55, v64
    v_max3_f32 v25, v65, v66, v67
    v_max3_f32 v22, v22, v68, v69
    v_max3_f32 v23, v23, v70, v71
    v_max3_f32 v24, v24, v72, v73
    v_max3_f32 v25, v25, v74, v75
    v_max3_f32 v22, v22, v76, v77
    v_max3_f32 v23, v23, v78, v79
    v_max3_f32 v24, v24, v80, v81
    v_max3_f32 v25, v25, v82, v83
    v_max3_f32 v22, v22, v84, v85
    v_max3_f32 v23, v23, v86, v87
    v_max3_f32 v24, v24, v56, v57
    v_max3_f32 v25, v25, v58, v59
    v_max3_f32 v22, v22, v60, v61
    v_max3_f32 v23, v23, v62, v63
    v_max3_f32 v24, v24, v88, v89
    v_max3_f32 v25, v25, v90, v91
    v_max3_f32 v22, v22, v92, v93
    v_max3_f32 v23, v23, v94, v95
    v_max3_f32 v24, v24, v96, v97
    v_max3_f32 v25, v25, v98, v99
    v_max3_f32 v22, v22, v23, v24
    v_max_f32 v22, v22, v25
    v_mov_b32 v23, v22
    s_nop 1
    v_permlane32_swap_b32 v22, v23
    v_max_f32 v22, v22, v23
    v_mov_b32 v23, v22
    s_nop 1
    v_permlane16_swap_b32 v22, v23
    v_max_f32 v22, v22, v23
    v_mul_f32 v24, s62, v22
    s_mov_b32 vcc_lo, 0xff00ff00
    s_mov_b32 vcc_hi, 0xff00ff00
    s_add_u32 m0, s56, 0
    s_add_u32 s61, s55, 32768
    buffer_load_dwordx4 v6, s[24:27], s61 offen offset:0 nt lds
    v_fma_f32 v48, v48, s62, -v24
    v_fma_f32 v49, v49, s62, -v24
    v_fma_f32 v50, v50, s62, -v24
    v_fma_f32 v51, v51, s62, -v24
    v_fma_f32 v52, v52, s62, -v24
    v_fma_f32 v53, v53, s62, -v24
    v_fma_f32 v54, v54, s62, -v24
    v_fma_f32 v55, v55, s62, -v24
    v_exp_f32 v48, v48
    v_exp_f32 v49, v49
    v_exp_f32 v50, v50
    v_exp_f32 v51, v51
    v_exp_f32 v52, v52
    v_exp_f32 v53, v53
    v_exp_f32 v54, v54
    v_exp_f32 v55, v55
    v_add_f32 v120, v48, v52
    v_add_f32 v121, v49, v53
    v_add_f32 v122, v50, v54
    v_add_f32 v123, v51, v55
    v_cvt_pk_bf16_f32 v48, v48, v49
    v_cvt_pk_bf16_f32 v49, v50, v51
    v_cvt_pk_bf16_f32 v50, v52, v53
    v_cvt_pk_bf16_f32 v51, v54, v55
    v_cndmask_b32 v52, 0, v48, vcc
    v_xor_b32 v48, v48, v52
    v_cndmask_b32 v53, 0, v49, vcc
    v_xor_b32 v49, v49, v53
    v_cndmask_b32 v54, 0, v50, vcc
    v_xor_b32 v50, v50, v54
    v_cndmask_b32 v55, 0, v51, vcc
    v_xor_b32 v51, v51, v55
    buffer_load_dwordx4 v7, s[24:27], s61 offen offset:1024 nt lds
    v_fma_f32 v64, v64, s62, -v24
    v_fma_f32 v65, v65, s62, -v24
    v_fma_f32 v66, v66, s62, -v24
    v_fma_f32 v67, v67, s62, -v24
    v_fma_f32 v68, v68, s62, -v24
    v_fma_f32 v69, v69, s62, -v24
    v_fma_f32 v70, v70, s62, -v24
    v_fma_f32 v71, v71, s62, -v24
    v_exp_f32 v64, v64
    v_exp_f32 v65, v65
    v_exp_f32 v66, v66
    v_exp_f32 v67, v67
    v_exp_f32 v68, v68
    v_exp_f32 v69, v69
    v_exp_f32 v70, v70
    v_exp_f32 v71, v71
    v_add_f32 v120, v120, v64
    v_add_f32 v121, v121, v65
    v_add_f32 v122, v122, v66
    v_add_f32 v123, v123, v67
    v_add_f32 v120, v120, v68
    v_add_f32 v121, v121, v69
    v_add_f32 v122, v122, v70
    v_add_f32 v123, v123, v71
    v_cvt_pk_bf16_f32 v64, v64, v65
    v_cvt_pk_bf16_f32 v65, v66, v67
    v_cvt_pk_bf16_f32 v66, v68, v69
    v_cvt_pk_bf16_f32 v67, v70, v71
    v_cndmask_b32 v68, 0, v64, vcc
    v_xor_b32 v64, v64, v68
    v_cndmask_b32 v69, 0, v65, vcc
    v_xor_b32 v65, v65, v69
    v_cndmask_b32 v70, 0, v66, vcc
    v_xor_b32 v66, v66, v70
    v_cndmask_b32 v71, 0, v67, vcc
    v_xor_b32 v67, v67, v71
    buffer_load_dwordx4 v6, s[24:27], s61 offen offset:2048 nt lds
    v_fma_f32 v72, v72, s62, -v24
    v_fma_f32 v73, v73, s62, -v24
    v_fma_f32 v74, v74, s62, -v24
    v_fma_f32 v75, v75, s62, -v24
    v_fma_f32 v76, v76, s62, -v24
    v_fma_f32 v77, v77, s62, -v24
    v_fma_f32 v78, v78, s62, -v24
    v_fma_f32 v79, v79, s62, -v24
    v_exp_f32 v72, v72
    v_exp_f32 v73, v73
    v_exp_f32 v74, v74
    v_exp_f32 v75, v75
    v_exp_f32 v76, v76
    v_exp_f32 v77, v77
    v_exp_f32 v78, v78
    v_exp_f32 v79, v79
    v_add_f32 v120, v120, v72
    v_add_f32 v121, v121, v73
    v_add_f32 v122, v122, v74
    v_add_f32 v123, v123, v75
    v_add_f32 v120, v120, v76
    v_add_f32 v121, v121, v77
    v_add_f32 v122, v122, v78
    v_add_f32 v123, v123, v79
    v_cvt_pk_bf16_f32 v72, v72, v73
    v_cvt_pk_bf16_f32 v73, v74, v75
    v_cvt_pk_bf16_f32 v74, v76, v77
    v_cvt_pk_bf16_f32 v75, v78, v79
    v_cndmask_b32 v76, 0, v72, vcc
    v_xor_b32 v72, v72, v76
    v_cndmask_b32 v77, 0, v73, vcc
    v_xor_b32 v73, v73, v77
    v_cndmask_b32 v78, 0, v74, vcc
    v_xor_b32 v74, v74, v78
    v_cndmask_b32 v79, 0, v75, vcc
    v_xor_b32 v75, v75, v79
    buffer_load_dwordx4 v7, s[24:27], s61 offen offset:3072 nt lds
    v_fma_f32 v80, v80, s62, -v24
    v_fma_f32 v81, v81, s62, -v24
    v_fma_f32 v82, v82, s62, -v24
    v_fma_f32 v83, v83, s62, -v24
    v_fma_f32 v84, v84, s62, -v24
    v_fma_f32 v85, v85, s62, -v24
    v_fma_f32 v86, v86, s62, -v24
    v_fma_f32 v87, v87, s62, -v24
    v_exp_f32 v80, v80
    v_exp_f32 v81, v81
    v_exp_f32 v82, v82
    v_exp_f32 v83, v83
    v_exp_f32 v84, v84
    v_exp_f32 v85, v85
    v_exp_f32 v86, v86
    v_exp_f32 v87, v87
    v_add_f32 v120, v120, v80
    v_add_f32 v121, v121, v81
    v_add_f32 v122, v122, v82
    v_add_f32 v123, v123, v83
    v_add_f32 v120, v120, v84
    v_add_f32 v121, v121, v85
    v_add_f32 v122, v122, v86
    v_add_f32 v123, v123, v87
    v_cvt_pk_bf16_f32 v80, v80, v81
    v_cvt_pk_bf16_f32 v81, v82, v83
    v_cvt_pk_bf16_f32 v82, v84, v85
    v_cvt_pk_bf16_f32 v83, v86, v87
    v_cndmask_b32 v84, 0, v80, vcc
    v_xor_b32 v80, v80, v84
    v_cndmask_b32 v85, 0, v81, vcc
    v_xor_b32 v81, v81, v85
    v_cndmask_b32 v86, 0, v82, vcc
    v_xor_b32 v82, v82, v86
    v_cndmask_b32 v87, 0, v83, vcc
    v_xor_b32 v83, v83, v87
    s_add_u32 m0, s56, 12288
    s_add_u32 s61, s55, 36864
    buffer_load_dwordx4 v6, s[24:27], s61 offen offset:0 nt lds
    v_fma_f32 v56, v56, s62, -v24
    v_fma_f32 v57, v57, s62, -v24
    v_fma_f32 v58, v58, s62, -v24
    v_fma_f32 v59, v59, s62, -v24
    v_fma_f32 v60, v60, s62, -v24
    v_fma_f32 v61, v61, s62, -v24
    v_fma_f32 v62, v62, s62, -v24
    v_fma_f32 v63, v63, s62, -v24
    v_exp_f32 v56, v56
    v_exp_f32 v57, v57
    v_exp_f32 v58, v58
    v_exp_f32 v59, v59
    v_exp_f32 v60, v60
    v_exp_f32 v61, v61
    v_exp_f32 v62, v62
    v_exp_f32 v63, v63
    v_add_f32 v120, v120, v56
    v_add_f32 v121, v121, v57
    v_add_f32 v122, v122, v58
    v_add_f32 v123, v123, v59
    v_add_f32 v120, v120, v60
    v_add_f32 v121, v121, v61
    v_add_f32 v122, v122, v62
    v_add_f32 v123, v123, v63
    v_cvt_pk_bf16_f32 v56, v56, v57
    v_cvt_pk_bf16_f32 v57, v58, v59
    v_cvt_pk_bf16_f32 v58, v60, v61
    v_cvt_pk_bf16_f32 v59, v62, v63
    v_cndmask_b32 v60, 0, v56, vcc
    v_xor_b32 v56, v56, v60
    v_cndmask_b32 v61, 0, v57, vcc
    v_xor_b32 v57, v57, v61
    v_cndmask_b32 v62, 0, v58, vcc
    v_xor_b32 v58, v58, v62
    v_cndmask_b32 v63, 0, v59, vcc
    v_xor_b32 v59, v59, v63
    buffer_load_dwordx4 v7, s[24:27], s61 offen offset:1024 nt lds
    v_fma_f32 v88, v88, s62, -v24
    v_fma_f32 v89, v89, s62, -v24
    v_fma_f32 v90, v90, s62, -v24
    v_fma_f32 v91, v91, s62, -v24
    v_fma_f32 v92, v92, s62, -v24
    v_fma_f32 v93, v93, s62, -v24
    v_fma_f32 v94, v94, s62, -v24
    v_fma_f32 v95, v95, s62, -v24
    v_exp_f32 v88, v88
    v_exp_f32 v89, v89
    v_exp_f32 v90, v90
    v_exp_f32 v91, v91
    v_exp_f32 v92, v92
    v_exp_f32 v93, v93
    v_exp_f32 v94, v94
    v_exp_f32 v95, v95
    v_add_f32 v120, v120, v88
    v_add_f32 v121, v121, v89
    v_add_f32 v122, v122, v90
    v_add_f32 v123, v123, v91
    v_add_f32 v120, v120, v92
    v_add_f32 v121, v121, v93
    v_add_f32 v122, v122, v94
    v_add_f32 v123, v123, v95
    v_cvt_pk_bf16_f32 v88, v88, v89
    v_cvt_pk_bf16_f32 v89, v90, v91
    v_cvt_pk_bf16_f32 v90, v92, v93
    v_cvt_pk_bf16_f32 v91, v94, v95
    v_cndmask_b32 v92, 0, v88, vcc
    v_xor_b32 v88, v88, v92
    v_cndmask_b32 v93, 0, v89, vcc
    v_xor_b32 v89, v89, v93
    v_cndmask_b32 v94, 0, v90, vcc
    v_xor_b32 v90, v90, v94
    v_cndmask_b32 v95, 0, v91, vcc
    v_xor_b32 v91, v91, v95
    buffer_load_dwordx4 v6, s[24:27], s61 offen offset:2048 nt lds
    v_fma_f32 v96, v96, s62, -v24
    v_fma_f32 v97, v97, s62, -v24
    v_fma_f32 v98, v98, s62, -v24
    v_fma_f32 v99, v99, s62, -v24
    v_exp_f32 v96, v96
    v_exp_f32 v97, v97
    v_exp_f32 v98, v98
    v_exp_f32 v99, v99
    v_add_f32 v120, v120, v96
    v_add_f32 v121, v121, v97
    v_add_f32 v122, v122, v98
    v_add_f32 v123, v123, v99
    v_cvt_pk_bf16_f32 v96, v96, v97
    v_cvt_pk_bf16_f32 v97, v98, v99
    v_cndmask_b32 v98, 0, v96, vcc
    v_xor_b32 v96, v96, v98
    v_cndmask_b32 v99, 0, v97, vcc
    v_xor_b32 v97, v97, v99
    v_add_f32 v120, v120, v121
    v_add_f32 v122, v122, v123
    v_add_f32 v23, v120, v122
    v_mov_b32 v24, v23
    s_nop 1
    v_permlane32_swap_b32 v23, v24
    v_add_f32 v23, v23, v24
    v_mov_b32 v24, v23
    s_nop 1
    v_permlane16_swap_b32 v23, v24
    v_add_f32 v23, v23, v24
    s_lshl_b32 s57, s52, 6
    s_add_u32 s57, s57, 154240
    v_lshl_add_u32 v24, v1, 3, s57
    s_mov_b64 exec, 0xff
    ds_write_b64 v24, v[22:23]
    s_mov_b64 exec, -1
    v_mov_b32 v29, 1
    s_mov_b64 exec, 1
    ds_add_u32 v31, v29 offset:12
    s_mov_b64 exec, -1
    s_waitcnt lgkmcnt(0)
    v_lshrrev_b32 v25, 4, v1
    v_and_b32 v26, 15, v1
    v_subrev_u32 v208, s56, v8
    v_add_u32 v208, 150016, v208
    v_subrev_u32 v209, s56, v9
    v_add_u32 v209, 150016, v209
    v_subrev_u32 v210, s56, v10
    v_add_u32 v210, 150016, v210
    v_subrev_u32 v211, s56, v11
    v_add_u32 v211, 150016, v211
    v_add_u32 v217, 0x10000, v21
    v_and_b32 v27, 7, v1
    v_mul_u32_u24 v27, 528, v27
    v_lshl_add_u32 v27, v25, 4, v27
    v_and_b32 v28, 8, v1
    v_lshl_add_u32 v27, v28, 5, v27
    s_mul_i32 s57, s52, 4224
    s_add_u32 s57, s57, 131072
    v_add_u32 v212, s57, v27
    v_lshrrev_b32 v24, 5, v1
    s_lshl_b32 s57, s52, 1
    v_add_u32 v27, s57, v24
    v_and_b32 v28, 31, v1
    v_mul_u32_u24 v29, 528, v27
    v_lshl_add_u32 v29, v28, 4, v29
    v_add_u32 v213, 131072, v29
    v_lshlrev_b32 v29, 4, v27
    v_add_u32 v214, 154112, v29
    v_lshlrev_b32 v29, 3, v28
    v_lshl_or_b32 v215, v27, 14, v29
    s_and_b32 s57, s64, 3
    s_lshl_b32 s57, s57, 17
    s_lshl_b32 s59, s65, 12
    s_add_u32 s57, s57, s59
    s_lshr_b32 s59, s64, 2
    s_lshl_b32 s59, s59, 8
    s_add_u32 s57, s57, s59
    v_add_u32 v215, s57, v215
    s_lshl_b32 s57, s52, 2
    v_add_u32 v27, s57, v25
    v_xor_b32 v28, v26, v27
    v_lshlrev_b32 v28, 4, v28
    v_lshl_or_b32 v28, v27, 8, v28
    v_add_u32 v192, 150016, v28
    v_lshrrev_b32 v28, 3, v1
    v_and_b32 v29, 7, v1
    v_lshlrev_b32 v29, 4, v29
    v_lshl_or_b32 v218, v28, 12, v29
    s_lshl_b32 s57, s53, 17
    s_lshl_b32 s59, s52, 15
    s_add_u32 s57, s57, s59
    s_lshl_b32 s59, s54, 7
    s_add_u32 s57, s57, s59
    s_add_u32 s57, s57, 1048576
    v_add_u32 v218, s57, v218
    s_lshl_b32 s57, s53, 5
    s_add_u32 s57, s57, s54
    s_lshl_b32 s98, s57, 12
    s_add_u32 s98, s98, 1048576
    s_lshl_b32 s59, s52, 5
    s_add_u32 s70, s98, s59
    s_lshl_b32 s59, s52, 10
    s_add_u32 s98, s98, s59
    v_lshrrev_b32 v28, 1, v1
    v_and_b32 v29, 1, v1
    v_lshlrev_b32 v27, 4, v29
    v_lshl_or_b32 v219, v28, 7, v27
    v_lshlrev_b32 v220, 11, v29
    v_lshl_add_u32 v220, v25, 2, v220
    s_lshl_b32 s59, s52, 12
    v_add_u32 v220, s59, v220
    s_and_b32 s59, s57, 1
    s_lshl_b32 s59, s59, 14
    s_lshr_b32 s57, s57, 1
    s_lshl_b32 s57, s57, 4
    s_add_u32 s57, s57, s59
    v_add_u32 v220, s57, v220
    v_lshlrev_b32 v216, 4, v1
    s_lshl_b32 s66, s54, 14
    s_lshl_b32 s59, s52, 10
    s_add_u32 s66, s66, s59
    s_add_u32 s67, s66, 4096
    s_add_u32 s68, s66, 8192
    s_add_u32 s69, s66, 12288
    v_lshlrev_b32 v222, 7, v1
    v_mov_b32 v194, 0x397001e0
    v_mov_b32 v195, 0x00070007
    v_mov_b32 v196, 0x38e001c0
    s_bfe_u32 s99, s60, 0x80000
    s_mul_i32 s99, s99, 0x2001
    s_and_b32 s99, s99, 0x00070007
    s_bfe_u32 s100, s60, 0x80008
    s_mul_i32 s100, s100, 0x2001
    s_and_b32 s100, s100, 0x00070007
    s_bfe_u32 s101, s60, 0x80010
    s_mul_i32 s101, s101, 0x2001
    s_and_b32 s101, s101, 0x00070007
    s_mov_b32 s3, 0x000f000f
    v_and_b32 v27, 1, v1
    v_cmp_eq_u32 vcc, 1, v27
    v_mov_b32 v27, s3
    v_mov_b32 v28, 0x1001
    v_cndmask_b32 v198, v194, v196, vcc
    v_cndmask_b32 v200, v27, v195, vcc
    v_cndmask_b32 v201, v28, 0, vcc
    v_mov_b32 v27, s100
    v_cndmask_b32 v202, 0, v27, vcc
    v_mov_b32 v27, s99
    v_mov_b32 v28, s101
    v_cndmask_b32 v203, v27, v28, vcc
    s_waitcnt vmcnt(6)
    s_cmp_ge_u32 s16, 2
    s_cbranch_scc1 L_sq99
    s_waitcnt vmcnt(5)
    s_cmp_ge_u32 s16, 1
    s_cbranch_scc1 L_sq99
    s_waitcnt vmcnt(4)
L_sq99:
    buffer_load_dwordx4 v7, s[24:27], s61 offen offset:3072 nt lds
    v_mov_b32 v29, 1
    s_mov_b64 exec, 1
    ds_add_u32 v31, v29 offset:8
    s_mov_b64 exec, -1
    ds_read_b32 v28, v31 offset:20
    ds_read_b64_tr_b16 v[224:225], v12 offset:4096
    ds_read_b64_tr_b16 v[226:227], v12 offset:8192
    ds_read_b64_tr_b16 v[240:241], v16 offset:4096
    ds_read_b64_tr_b16 v[242:243], v16 offset:8192
    ds_read_b64_tr_b16 v[228:229], v13 offset:4096
    ds_read_b64_tr_b16 v[230:231], v13 offset:8192
    ds_read_b64_tr_b16 v[244:245], v17 offset:4096
    ds_read_b64_tr_b16 v[246:247], v17 offset:8192
    ds_read_b64_tr_b16 v[232:233], v14 offset:4096
    ds_read_b64_tr_b16 v[234:235], v14 offset:8192
    ds_read_b64_tr_b16 v[248:249], v18 offset:4096
    ds_read_b64_tr_b16 v[250:251], v18 offset:8192
    ds_read_b64_tr_b16 v[236:237], v15 offset:4096
    ds_read_b64_tr_b16 v[238:239], v15 offset:8192
    ds_read_b64_tr_b16 v[252:253], v19 offset:4096
    ds_read_b64_tr_b16 v[254:255], v19 offset:8192
    s_waitcnt lgkmcnt(14)
    v_mfma_f32_16x16x32_bf16 v[128:131], v[224:227], v[48:51], 0
    s_waitcnt lgkmcnt(12)
    v_mfma_f32_16x16x32_bf16 v[128:131], v[240:243], v[52:55], v[128:131]
    s_waitcnt lgkmcnt(10)
    v_mfma_f32_16x16x32_bf16 v[132:135], v[228:231], v[48:51], 0
    s_waitcnt lgkmcnt(8)
    v_mfma_f32_16x16x32_bf16 v[132:135], v[244:247], v[52:55], v[132:135]
    s_waitcnt lgkmcnt(6)
    v_mfma_f32_16x16x32_bf16 v[136:139], v[232:235], v[48:51], 0
    s_waitcnt lgkmcnt(4)
    v_mfma_f32_16x16x32_bf16 v[136:139], v[248:251], v[52:55], v[136:139]
    s_waitcnt lgkmcnt(2)
    v_mfma_f32_16x16x32_bf16 v[140:143], v[236:239], v[48:51], 0
    s_waitcnt lgkmcnt(0)
    v_mfma_f32_16x16x32_bf16 v[140:143], v[252:255], v[52:55], v[140:143]
    v_readfirstlane_b32 s16, v28
    s_waitcnt vmcnt(6)
    s_cmp_ge_u32 s16, 2
    s_cbranch_scc1 L_sq100
    s_waitcnt vmcnt(5)
    s_cmp_ge_u32 s16, 1
    s_cbranch_scc1 L_sq100
    s_waitcnt vmcnt(4)
L_sq100:
    s_add_u32 m0, s56, 4096
    s_add_u32 s61, s55, 65536
    buffer_load_dwordx4 v6, s[24:27], s61 offen offset:0 nt lds
    s_waitcnt vmcnt(6)
    s_cmp_ge_u32 s16, 2
    s_cbranch_scc1 L_sq101
    s_waitcnt vmcnt(5)
    s_cmp_ge_u32 s16, 1
    s_cbranch_scc1 L_sq101
    s_waitcnt vmcnt(4)
L_sq101:
    buffer_load_dwordx4 v7, s[24:27], s61 offen offset:1024 nt lds
    s_waitcnt vmcnt(6)
    s_cmp_ge_u32 s16, 2
    s_cbranch_scc1 L_sq102
    s_waitcnt vmcnt(5)
    s_cmp_ge_u32 s16, 1
    s_cbranch_scc1 L_sq102
    s_waitcnt vmcnt(4)
L_sq102:
    buffer_load_dwordx4 v6, s[24:27], s61 offen offset:2048 nt lds
    s_waitcnt vmcnt(6)
    s_cmp_ge_u32 s16, 2
    s_cbranch_scc1 L_sq103
    s_waitcnt vmcnt(5)
    s_cmp_ge_u32 s16, 1
    s_cbranch_scc1 L_sq103
    s_waitcnt vmcnt(4)
L_sq103:
    buffer_load_dwordx4 v7, s[24:27], s61 offen offset:3072 nt lds
    s_waitcnt vmcnt(6)
    s_cmp_ge_u32 s16, 2
    s_cbranch_scc1 L_sq104
    s_waitcnt vmcnt(5)
    s_cmp_ge_u32 s16, 1
    s_cbranch_scc1 L_sq104
    s_waitcnt vmcnt(4)
L_sq104:
    s_add_u32 m0, s56, 8192
    s_add_u32 s61, s55, 69632
    buffer_load_dwordx4 v6, s[24:27], s61 offen offset:0 nt lds
    s_waitcnt vmcnt(6)
    s_cmp_ge_u32 s16, 2
    s_cbranch_scc1 L_sq105
    s_waitcnt vmcnt(5)
    s_cmp_ge_u32 s16, 1
    s_cbranch_scc1 L_sq105
    s_waitcnt vmcnt(4)
L_sq105:
    buffer_load_dwordx4 v7, s[24:27], s61 offen offset:1024 nt lds
    s_waitcnt vmcnt(6)
    s_cmp_ge_u32 s16, 2
    s_cbranch_scc1 L_sq106
    s_waitcnt vmcnt(5)
    s_cmp_ge_u32 s16, 1
    s_cbranch_scc1 L_sq106
    s_waitcnt vmcnt(4)
L_sq106:
    buffer_load_dwordx4 v6, s[24:27], s61 offen offset:2048 nt lds
    ds_read_b32 v28, v31 offset:20
    ds_read_b64_tr_b16 v[224:225], v12 offset:0
    ds_read_b64_tr_b16 v[226:227], v12 offset:12288
    ds_read_b64_tr_b16 v[240:241], v16 offset:0
    ds_read_b64_tr_b16 v[242:243], v16 offset:12288
    ds_read_b64_tr_b16 v[228:229], v13 offset:0
    ds_read_b64_tr_b16 v[230:231], v13 offset:12288
    ds_read_b64_tr_b16 v[244:245], v17 offset:0
    ds_read_b64_tr_b16 v[246:247], v17 offset:12288
    ds_read_b64_tr_b16 v[232:233], v14 offset:0
    ds_read_b64_tr_b16 v[234:235], v14 offset:12288
    ds_read_b64_tr_b16 v[248:249], v18 offset:0
    ds_read_b64_tr_b16 v[250:251], v18 offset:12288
    ds_read_b64_tr_b16 v[236:237], v15 offset:0
    ds_read_b64_tr_b16 v[238:239], v15 offset:12288
    ds_read_b64_tr_b16 v[252:253], v19 offset:0
    ds_read_b64_tr_b16 v[254:255], v19 offset:12288
    s_waitcnt lgkmcnt(14)
    v_mfma_f32_16x16x32_bf16 v[128:131], v[224:227], v[64:67], v[128:131]
    s_waitcnt lgkmcnt(12)
    v_mfma_f32_16x16x32_bf16 v[128:131], v[240:243], v[68:71], v[128:131]
    s_waitcnt lgkmcnt(10)
    v_mfma_f32_16x16x32_bf16 v[132:135], v[228:231], v[64:67], v[132:135]
    s_waitcnt lgkmcnt(8)
    v_mfma_f32_16x16x32_bf16 v[132:135], v[244:247], v[68:71], v[132:135]
    s_waitcnt lgkmcnt(6)
    v_mfma_f32_16x16x32_bf16 v[136:139], v[232:235], v[64:67], v[136:139]
    s_waitcnt lgkmcnt(4)
    v_mfma_f32_16x16x32_bf16 v[136:139], v[248:251], v[68:71], v[136:139]
    s_waitcnt lgkmcnt(2)
    v_mfma_f32_16x16x32_bf16 v[140:143], v[236:239], v[64:67], v[140:143]
    s_waitcnt lgkmcnt(0)
    v_mfma_f32_16x16x32_bf16 v[140:143], v[252:255], v[68:71], v[140:143]
    v_readfirstlane_b32 s16, v28
    s_waitcnt vmcnt(6)
    s_cmp_ge_u32 s16, 2
    s_cbranch_scc1 L_sq107
    s_waitcnt vmcnt(5)
    s_cmp_ge_u32 s16, 1
    s_cbranch_scc1 L_sq107
    s_waitcnt vmcnt(4)
L_sq107:
    buffer_load_dwordx4 v7, s[24:27], s61 offen offset:3072 nt lds
    s_waitcnt vmcnt(6)
    s_cmp_ge_u32 s16, 2
    s_cbranch_scc1 L_sq108
    s_waitcnt vmcnt(5)
    s_cmp_ge_u32 s16, 1
    s_cbranch_scc1 L_sq108
    s_waitcnt vmcnt(4)
L_sq108:
    s_add_u32 m0, s56, 0
    s_add_u32 s61, s55, 98304
    buffer_load_dwordx4 v6, s[24:27], s61 offen offset:0 nt lds
    s_waitcnt vmcnt(6)
    s_cmp_ge_u32 s16, 2
    s_cbranch_scc1 L_sq109
    s_waitcnt vmcnt(5)
    s_cmp_ge_u32 s16, 1
    s_cbranch_scc1 L_sq109
    s_waitcnt vmcnt(4)
L_sq109:
    buffer_load_dwordx4 v7, s[24:27], s61 offen offset:1024 nt lds
    s_waitcnt vmcnt(6)
    s_cmp_ge_u32 s16, 2
    s_cbranch_scc1 L_sq110
    s_waitcnt vmcnt(5)
    s_cmp_ge_u32 s16, 1
    s_cbranch_scc1 L_sq110
    s_waitcnt vmcnt(4)
L_sq110:
    buffer_load_dwordx4 v6, s[24:27], s61 offen offset:2048 nt lds
    s_waitcnt vmcnt(6)
    s_cmp_ge_u32 s16, 2
    s_cbranch_scc1 L_sq111
    s_waitcnt vmcnt(5)
    s_cmp_ge_u32 s16, 1
    s_cbranch_scc1 L_sq111
    s_waitcnt vmcnt(4)
L_sq111:
    buffer_load_dwordx4 v7, s[24:27], s61 offen offset:3072 nt lds
    s_waitcnt vmcnt(6)
    s_cmp_ge_u32 s16, 2
    s_cbranch_scc1 L_sq112
    s_waitcnt vmcnt(5)
    s_cmp_ge_u32 s16, 1
    s_cbranch_scc1 L_sq112
    s_waitcnt vmcnt(4)
L_sq112:
    s_add_u32 m0, s56, 12288
    s_add_u32 s61, s55, 102400
    buffer_load_dwordx4 v6, s[24:27], s61 offen offset:0 nt lds
    s_waitcnt vmcnt(6)
    s_cmp_ge_u32 s16, 2
    s_cbranch_scc1 L_sq113
    s_waitcnt vmcnt(5)
    s_cmp_ge_u32 s16, 1
    s_cbranch_scc1 L_sq113
    s_waitcnt vmcnt(4)
L_sq113:
    buffer_load_dwordx4 v7, s[24:27], s61 offen offset:1024 nt lds
    s_waitcnt vmcnt(6)
    s_cmp_ge_u32 s16, 2
    s_cbranch_scc1 L_sq114
    s_waitcnt vmcnt(5)
    s_cmp_ge_u32 s16, 1
    s_cbranch_scc1 L_sq114
    s_waitcnt vmcnt(4)
L_sq114:
    buffer_load_dwordx4 v6, s[24:27], s61 offen offset:2048 nt lds
    ds_read_b32 v28, v31 offset:20
    ds_read_b64_tr_b16 v[224:225], v12 offset:4096
    ds_read_b64_tr_b16 v[226:227], v12 offset:8192
    ds_read_b64_tr_b16 v[240:241], v16 offset:4096
    ds_read_b64_tr_b16 v[242:243], v16 offset:8192
    ds_read_b64_tr_b16 v[228:229], v13 offset:4096
    ds_read_b64_tr_b16 v[230:231], v13 offset:8192
    ds_read_b64_tr_b16 v[244:245], v17 offset:4096
    ds_read_b64_tr_b16 v[246:247], v17 offset:8192
    ds_read_b64_tr_b16 v[232:233], v14 offset:4096
    ds_read_b64_tr_b16 v[234:235], v14 offset:8192
    ds_read_b64_tr_b16 v[248:249], v18 offset:4096
    ds_read_b64_tr_b16 v[250:251], v18 offset:8192
    ds_read_b64_tr_b16 v[236:237], v15 offset:4096
    ds_read_b64_tr_b16 v[238:239], v15 offset:8192
    ds_read_b64_tr_b16 v[252:253], v19 offset:4096
    ds_read_b64_tr_b16 v[254:255], v19 offset:8192
    s_waitcnt lgkmcnt(14)
    v_mfma_f32_16x16x32_bf16 v[128:131], v[224:227], v[72:75], v[128:131]
    s_waitcnt lgkmcnt(12)
    v_mfma_f32_16x16x32_bf16 v[128:131], v[240:243], v[76:79], v[128:131]
    s_waitcnt lgkmcnt(10)
    v_mfma_f32_16x16x32_bf16 v[132:135], v[228:231], v[72:75], v[132:135]
    s_waitcnt lgkmcnt(8)
    v_mfma_f32_16x16x32_bf16 v[132:135], v[244:247], v[76:79], v[132:135]
    s_waitcnt lgkmcnt(6)
    v_mfma_f32_16x16x32_bf16 v[136:139], v[232:235], v[72:75], v[136:139]
    s_waitcnt lgkmcnt(4)
    v_mfma_f32_16x16x32_bf16 v[136:139], v[248:251], v[76:79], v[136:139]
    s_waitcnt lgkmcnt(2)
    v_mfma_f32_16x16x32_bf16 v[140:143], v[236:239], v[72:75], v[140:143]
    s_waitcnt lgkmcnt(0)
    v_mfma_f32_16x16x32_bf16 v[140:143], v[252:255], v[76:79], v[140:143]
    v_readfirstlane_b32 s16, v28
    s_waitcnt vmcnt(6)
    s_cmp_ge_u32 s16, 2
    s_cbranch_scc1 L_sq115
    s_waitcnt vmcnt(5)
    s_cmp_ge_u32 s16, 1
    s_cbranch_scc1 L_sq115
    s_waitcnt vmcnt(4)
L_sq115:
    buffer_load_dwordx4 v7, s[24:27], s61 offen offset:3072 nt lds
    v_mov_b32 v29, 1
    s_mov_b64 exec, 1
    ds_add_u32 v31, v29 offset:8
    s_mov_b64 exec, -1
    s_waitcnt vmcnt(6)
    s_cmp_ge_u32 s16, 2
    s_cbranch_scc1 L_sq116
    s_waitcnt vmcnt(5)
    s_cmp_ge_u32 s16, 1
    s_cbranch_scc1 L_sq116
    s_waitcnt vmcnt(4)
L_sq116:
    s_add_u32 m0, s56, 4096
    s_add_u32 s61, s55, 131072
    buffer_load_dwordx4 v6, s[24:27], s61 offen offset:0 nt lds
    s_waitcnt vmcnt(6)
    s_cmp_ge_u32 s16, 2
    s_cbranch_scc1 L_sq117
    s_waitcnt vmcnt(5)
    s_cmp_ge_u32 s16, 1
    s_cbranch_scc1 L_sq117
    s_waitcnt vmcnt(4)
L_sq117:
    buffer_load_dwordx4 v7, s[24:27], s61 offen offset:1024 nt lds
    s_waitcnt vmcnt(6)
    s_cmp_ge_u32 s16, 2
    s_cbranch_scc1 L_sq118
    s_waitcnt vmcnt(5)
    s_cmp_ge_u32 s16, 1
    s_cbranch_scc1 L_sq118
    s_waitcnt vmcnt(4)
L_sq118:
    buffer_load_dwordx4 v6, s[24:27], s61 offen offset:2048 nt lds
    s_waitcnt vmcnt(6)
    s_cmp_ge_u32 s16, 2
    s_cbranch_scc1 L_sq119
    s_waitcnt vmcnt(5)
    s_cmp_ge_u32 s16, 1
    s_cbranch_scc1 L_sq119
    s_waitcnt vmcnt(4)
L_sq119:
    buffer_load_dwordx4 v7, s[24:27], s61 offen offset:3072 nt lds
    s_waitcnt vmcnt(6)
    s_cmp_ge_u32 s16, 2
    s_cbranch_scc1 L_sq120
    s_waitcnt vmcnt(5)
    s_cmp_ge_u32 s16, 1
    s_cbranch_scc1 L_sq120
    s_waitcnt vmcnt(4)
L_sq120:
    s_add_u32 m0, s56, 8192
    s_add_u32 s61, s55, 135168
    buffer_load_dwordx4 v6, s[24:27], s61 offen offset:0 nt lds
    s_waitcnt vmcnt(6)
    s_cmp_ge_u32 s16, 2
    s_cbranch_scc1 L_sq121
    s_waitcnt vmcnt(5)
    s_cmp_ge_u32 s16, 1
    s_cbranch_scc1 L_sq121
    s_waitcnt vmcnt(4)
L_sq121:
    buffer_load_dwordx4 v7, s[24:27], s61 offen offset:1024 nt lds
    s_waitcnt vmcnt(6)
    s_cmp_ge_u32 s16, 2
    s_cbranch_scc1 L_sq122
    s_waitcnt vmcnt(5)
    s_cmp_ge_u32 s16, 1
    s_cbranch_scc1 L_sq122
    s_waitcnt vmcnt(4)
L_sq122:
    buffer_load_dwordx4 v6, s[24:27], s61 offen offset:2048 nt lds
    ds_read_b32 v28, v31 offset:20
    ds_read_b64_tr_b16 v[224:225], v12 offset:0
    ds_read_b64_tr_b16 v[226:227], v12 offset:12288
    ds_read_b64_tr_b16 v[240:241], v16 offset:0
    ds_read_b64_tr_b16 v[242:243], v16 offset:12288
    ds_read_b64_tr_b16 v[228:229], v13 offset:0
    ds_read_b64_tr_b16 v[230:231], v13 offset:12288
    ds_read_b64_tr_b16 v[244:245], v17 offset:0
    ds_read_b64_tr_b16 v[246:247], v17 offset:12288
    ds_read_b64_tr_b16 v[232:233], v14 offset:0
    ds_read_b64_tr_b16 v[234:235], v14 offset:12288
    ds_read_b64_tr_b16 v[248:249], v18 offset:0
    ds_read_b64_tr_b16 v[250:251], v18 offset:12288
    ds_read_b64_tr_b16 v[236:237], v15 offset:0
    ds_read_b64_tr_b16 v[238:239], v15 offset:12288
    ds_read_b64_tr_b16 v[252:253], v19 offset:0
    ds_read_b64_tr_b16 v[254:255], v19 offset:12288
    s_waitcnt lgkmcnt(14)
    v_mfma_f32_16x16x32_bf16 v[128:131], v[224:227], v[80:83], v[128:131]
    s_waitcnt lgkmcnt(12)
    v_mfma_f32_16x16x32_bf16 v[128:131], v[240:243], v[84:87], v[128:131]
    s_waitcnt lgkmcnt(10)
    v_mfma_f32_16x16x32_bf16 v[132:135], v[228:231], v[80:83], v[132:135]
    s_waitcnt lgkmcnt(8)
    v_mfma_f32_16x16x32_bf16 v[132:135], v[244:247], v[84:87], v[132:135]
    s_waitcnt lgkmcnt(6)
    v_mfma_f32_16x16x32_bf16 v[136:139], v[232:235], v[80:83], v[136:139]
    s_waitcnt lgkmcnt(4)
    v_mfma_f32_16x16x32_bf16 v[136:139], v[248:251], v[84:87], v[136:139]
    s_waitcnt lgkmcnt(2)
    v_mfma_f32_16x16x32_bf16 v[140:143], v[236:239], v[80:83], v[140:143]
    s_waitcnt lgkmcnt(0)
    v_mfma_f32_16x16x32_bf16 v[140:143], v[252:255], v[84:87], v[140:143]
    v_readfirstlane_b32 s16, v28
    s_waitcnt vmcnt(6)
    s_cmp_ge_u32 s16, 2
    s_cbranch_scc1 L_sq123
    s_waitcnt vmcnt(5)
    s_cmp_ge_u32 s16, 1
    s_cbranch_scc1 L_sq123
    s_waitcnt vmcnt(4)
L_sq123:
    buffer_load_dwordx4 v7, s[24:27], s61 offen offset:3072 nt lds
    s_waitcnt vmcnt(6)
    s_cmp_ge_u32 s16, 2
    s_cbranch_scc1 L_sq124
    s_waitcnt vmcnt(5)
    s_cmp_ge_u32 s16, 1
    s_cbranch_scc1 L_sq124
    s_waitcnt vmcnt(4)
L_sq124:
    s_add_u32 m0, s56, 0
    s_add_u32 s61, s55, 163840
    buffer_load_dwordx4 v6, s[24:27], s61 offen offset:0 nt lds
    s_waitcnt vmcnt(6)
    s_cmp_ge_u32 s16, 2
    s_cbranch_scc1 L_sq125
    s_waitcnt vmcnt(5)
    s_cmp_ge_u32 s16, 1
    s_cbranch_scc1 L_sq125
    s_waitcnt vmcnt(4)
L_sq125:
    buffer_load_dwordx4 v7, s[24:27], s61 offen offset:1024 nt lds
    s_waitcnt vmcnt(6)
    s_cmp_ge_u32 s16, 2
    s_cbranch_scc1 L_sq126
    s_waitcnt vmcnt(5)
    s_cmp_ge_u32 s16, 1
    s_cbranch_scc1 L_sq126
    s_waitcnt vmcnt(4)
L_sq126:
    buffer_load_dwordx4 v6, s[24:27], s61 offen offset:2048 nt lds
    s_waitcnt vmcnt(6)
    s_cmp_ge_u32 s16, 2
    s_cbranch_scc1 L_sq127
    s_waitcnt vmcnt(5)
    s_cmp_ge_u32 s16, 1
    s_cbranch_scc1 L_sq127
    s_waitcnt vmcnt(4)
L_sq127:
    buffer_load_dwordx4 v7, s[24:27], s61 offen offset:3072 nt lds
    s_waitcnt vmcnt(6)
    s_cmp_ge_u32 s16, 2
    s_cbranch_scc1 L_sq128
    s_waitcnt vmcnt(5)
    s_cmp_ge_u32 s16, 1
    s_cbranch_scc1 L_sq128
    s_waitcnt vmcnt(4)
L_sq128:
    s_add_u32 m0, s56, 12288
    s_add_u32 s61, s55, 167936
    buffer_load_dwordx4 v6, s[24:27], s61 offen offset:0 nt lds
    s_waitcnt vmcnt(6)
    s_cmp_ge_u32 s16, 2
    s_cbranch_scc1 L_sq129
    s_waitcnt vmcnt(5)
    s_cmp_ge_u32 s16, 1
    s_cbranch_scc1 L_sq129
    s_waitcnt vmcnt(4)
L_sq129:
    buffer_load_dwordx4 v7, s[24:27], s61 offen offset:1024 nt lds
    s_waitcnt vmcnt(6)
    s_cmp_ge_u32 s16, 2
    s_cbranch_scc1 L_sq130
    s_waitcnt vmcnt(5)
    s_cmp_ge_u32 s16, 1
    s_cbranch_scc1 L_sq130
    s_waitcnt vmcnt(4)
L_sq130:
    buffer_load_dwordx4 v6, s[24:27], s61 offen offset:2048 nt lds
    ds_read_b32 v28, v31 offset:20
    ds_read_b64_tr_b16 v[224:225], v12 offset:4096
    ds_read_b64_tr_b16 v[226:227], v12 offset:8192
    ds_read_b64_tr_b16 v[240:241], v16 offset:4096
    ds_read_b64_tr_b16 v[242:243], v16 offset:8192
    ds_read_b64_tr_b16 v[228:229], v13 offset:4096
    ds_read_b64_tr_b16 v[230:231], v13 offset:8192
    ds_read_b64_tr_b16 v[244:245], v17 offset:4096
    ds_read_b64_tr_b16 v[246:247], v17 offset:8192
    ds_read_b64_tr_b16 v[232:233], v14 offset:4096
    ds_read_b64_tr_b16 v[234:235], v14 offset:8192
    ds_read_b64_tr_b16 v[248:249], v18 offset:4096
    ds_read_b64_tr_b16 v[250:251], v18 offset:8192
    ds_read_b64_tr_b16 v[236:237], v15 offset:4096
    ds_read_b64_tr_b16 v[238:239], v15 offset:8192
    ds_read_b64_tr_b16 v[252:253], v19 offset:4096
    ds_read_b64_tr_b16 v[254:255], v19 offset:8192
    s_waitcnt lgkmcnt(14)
    v_mfma_f32_16x16x32_bf16 v[128:131], v[224:227], v[56:59], v[128:131]
    s_waitcnt lgkmcnt(12)
    v_mfma_f32_16x16x32_bf16 v[128:131], v[240:243], v[60:63], v[128:131]
    s_waitcnt lgkmcnt(10)
    v_mfma_f32_16x16x32_bf16 v[132:135], v[228:231], v[56:59], v[132:135]
    s_waitcnt lgkmcnt(8)
    v_mfma_f32_16x16x32_bf16 v[132:135], v[244:247], v[60:63], v[132:135]
    s_waitcnt lgkmcnt(6)
    v_mfma_f32_16x16x32_bf16 v[136:139], v[232:235], v[56:59], v[136:139]
    s_waitcnt lgkmcnt(4)
    v_mfma_f32_16x16x32_bf16 v[136:139], v[248:251], v[60:63], v[136:139]
    s_waitcnt lgkmcnt(2)
    v_mfma_f32_16x16x32_bf16 v[140:143], v[236:239], v[56:59], v[140:143]
    s_waitcnt lgkmcnt(0)
    v_mfma_f32_16x16x32_bf16 v[140:143], v[252:255], v[60:63], v[140:143]
    v_readfirstlane_b32 s16, v28
    s_waitcnt vmcnt(6)
    s_cmp_ge_u32 s16, 2
    s_cbranch_scc1 L_sq131
    s_waitcnt vmcnt(5)
    s_cmp_ge_u32 s16, 1
    s_cbranch_scc1 L_sq131
    s_waitcnt vmcnt(4)
L_sq131:
    buffer_load_dwordx4 v7, s[24:27], s61 offen offset:3072 nt lds
    s_waitcnt vmcnt(6)
    s_cmp_ge_u32 s16, 2
    s_cbranch_scc1 L_sq132
    s_waitcnt vmcnt(5)
    s_cmp_ge_u32 s16, 1
    s_cbranch_scc1 L_sq132
    s_waitcnt vmcnt(4)
L_sq132:
    s_add_u32 m0, s56, 4096
    s_add_u32 s61, s97, 196608
    buffer_load_dwordx4 v6, s[24:27], s61 offen offset:0 nt lds
    s_waitcnt vmcnt(6)
    s_cmp_ge_u32 s16, 2
    s_cbranch_scc1 L_sq133
    s_waitcnt vmcnt(5)
    s_cmp_ge_u32 s16, 1
    s_cbranch_scc1 L_sq133
    s_waitcnt vmcnt(4)
L_sq133:
    buffer_load_dwordx4 v7, s[24:27], s61 offen offset:1024 nt lds
    s_waitcnt vmcnt(6)
    s_cmp_ge_u32 s16, 2
    s_cbranch_scc1 L_sq134
    s_waitcnt vmcnt(5)
    s_cmp_ge_u32 s16, 1
    s_cbranch_scc1 L_sq134
    s_waitcnt vmcnt(4)
L_sq134:
    buffer_load_dwordx4 v6, s[24:27], s61 offen offset:2048 nt lds
    s_waitcnt vmcnt(6)
    s_cmp_ge_u32 s16, 2
    s_cbranch_scc1 L_sq135
    s_waitcnt vmcnt(5)
    s_cmp_ge_u32 s16, 1
    s_cbranch_scc1 L_sq135
    s_waitcnt vmcnt(4)
L_sq135:
    buffer_load_dwordx4 v7, s[24:27], s61 offen offset:3072 nt lds
    s_waitcnt vmcnt(4)
    ds_read_b32 v28, v31 offset:20
    ds_read_b64_tr_b16 v[224:225], v12 offset:0
    ds_read_b64_tr_b16 v[226:227], v12 offset:12288
    ds_read_b64_tr_b16 v[240:241], v16 offset:0
    ds_read_b64_tr_b16 v[242:243], v16 offset:12288
    ds_read_b64_tr_b16 v[228:229], v13 offset:0
    ds_read_b64_tr_b16 v[230:231], v13 offset:12288
    ds_read_b64_tr_b16 v[244:245], v17 offset:0
    ds_read_b64_tr_b16 v[246:247], v17 offset:12288
    ds_read_b64_tr_b16 v[232:233], v14 offset:0
    ds_read_b64_tr_b16 v[234:235], v14 offset:12288
    ds_read_b64_tr_b16 v[248:249], v18 offset:0
    ds_read_b64_tr_b16 v[250:251], v18 offset:12288
    ds_read_b64_tr_b16 v[236:237], v15 offset:0
    ds_read_b64_tr_b16 v[238:239], v15 offset:12288
    ds_read_b64_tr_b16 v[252:253], v19 offset:0
    ds_read_b64_tr_b16 v[254:255], v19 offset:12288
    s_waitcnt lgkmcnt(14)
    v_mfma_f32_16x16x32_bf16 v[128:131], v[224:227], v[88:91], v[128:131]
    s_waitcnt lgkmcnt(12)
    v_mfma_f32_16x16x32_bf16 v[128:131], v[240:243], v[92:95], v[128:131]
    s_waitcnt lgkmcnt(10)
    v_mfma_f32_16x16x32_bf16 v[132:135], v[228:231], v[88:91], v[132:135]
    s_waitcnt lgkmcnt(8)
    v_mfma_f32_16x16x32_bf16 v[132:135], v[244:247], v[92:95], v[132:135]
    s_waitcnt lgkmcnt(6)
    v_mfma_f32_16x16x32_bf16 v[136:139], v[232:235], v[88:91], v[136:139]
    s_waitcnt lgkmcnt(4)
    v_mfma_f32_16x16x32_bf16 v[136:139], v[248:251], v[92:95], v[136:139]
    s_waitcnt lgkmcnt(2)
    v_mfma_f32_16x16x32_bf16 v[140:143], v[236:239], v[88:91], v[140:143]
    s_waitcnt lgkmcnt(0)
    v_mfma_f32_16x16x32_bf16 v[140:143], v[252:255], v[92:95], v[140:143]
    v_readfirstlane_b32 s16, v28
    s_cmp_ge_u32 s16, 2
    s_cbranch_scc1 L_sq136
    s_waitcnt vmcnt(3)
    s_cmp_ge_u32 s16, 1
    s_cbranch_scc1 L_sq136
    s_waitcnt vmcnt(2)
L_sq136:
    s_add_u32 m0, s56, 24576
    s_add_u32 s61, s96, 0
    buffer_load_dwordx4 v20, s[32:35], s61 offen offset:0 nt lds
    s_waitcnt vmcnt(4)
    s_cmp_ge_u32 s16, 2
    s_cbranch_scc1 L_sq137
    s_waitcnt vmcnt(3)
    s_cmp_ge_u32 s16, 1
    s_cbranch_scc1 L_sq137
    s_waitcnt vmcnt(2)
L_sq137:
    s_add_u32 s61, s96, 15360
    buffer_load_dwordx4 v20, s[32:35], s61 offen offset:1024 nt lds
    s_waitcnt vmcnt(2)
    ds_read_b64_tr_b16 v[224:225], v12 offset:4096
    ds_read_b64_tr_b16 v[226:227], v16 offset:4096
    ds_read_b64_tr_b16 v[228:229], v13 offset:4096
    ds_read_b64_tr_b16 v[230:231], v17 offset:4096
    ds_read_b64_tr_b16 v[232:233], v14 offset:4096
    ds_read_b64_tr_b16 v[234:235], v18 offset:4096
    ds_read_b64_tr_b16 v[236:237], v15 offset:4096
    ds_read_b64_tr_b16 v[238:239], v19 offset:4096
    s_add_u32 s61, s96, 30720
    buffer_load_dwordx4 v20, s[32:35], s61 offen offset:2048 nt lds
    s_add_u32 s61, s96, 46080
    buffer_load_dwordx4 v20, s[32:35], s61 offen offset:3072 nt lds
    s_waitcnt lgkmcnt(6)
    v_mfma_f32_16x16x32_bf16 v[128:131], v[224:227], v[96:99], v[128:131]
    s_waitcnt lgkmcnt(4)
    v_mfma_f32_16x16x32_bf16 v[132:135], v[228:231], v[96:99], v[132:135]
    s_waitcnt lgkmcnt(2)
    v_mfma_f32_16x16x32_bf16 v[136:139], v[232:235], v[96:99], v[136:139]
    s_waitcnt lgkmcnt(0)
    v_mfma_f32_16x16x32_bf16 v[140:143], v[236:239], v[96:99], v[140:143]
    s_branch L_tail
L_ctrl:
    v_lshlrev_b32 v2, 4, v1
    s_mov_b32 s63, 0
    s_mov_b32 s62, 0x3e0293ee
    v_mov_b32 v4, 0x397001e0
    v_mov_b32 v5, 0x00070007
    v_mov_b32 v6, 0x38e001c0
    s_lshr_b32 s57, s54, 3
    s_add_u32 s57, s57, s53
    s_and_b32 s57, s57, 3
    s_mul_i32 s57, s57, 2304
    s_add_u32 s57, s57, 2396160
    s_add_u32 s66, s18, s57
    s_addc_u32 s67, s19, 0
    s_load_dword s24, s[66:67], 0
    s_load_dword s25, s[66:67], 256
    s_load_dword s26, s[66:67], 512
    s_load_dword s27, s[66:67], 768
    s_load_dword s28, s[66:67], 1024
    s_mul_i32 s57, s53, 4352
    s_add_u32 s57, s57, 2527232
    buffer_load_dwordx2 v[12:13], v9, s[40:43], s57 offen sc1
    s_add_u32 s36, s18, s57
    s_addc_u32 s37, s19, 0
    s_getreg_b32 s57, hwreg(HW_REG_XCC_ID, 0, 4)
    s_lshl_b32 s58, s57, 3
    s_lshl_b64 s[44:45], 1, s58
    s_lshl_b64 s[46:47], 32, s58
    s_cmp_lt_u32 s57, 8
    s_cselect_b64 s[44:45], s[44:45], -1
    s_waitcnt vmcnt(0) lgkmcnt(0)
    v_add_u32 v8, 0x01010101, v8
    s_nop 0
    v_readfirstlane_b32 s60, v8
    v_readfirstlane_b32 s38, v12
    v_readfirstlane_b32 s39, v13
    s_nop 0
    s_bfe_u32 s99, s60, 0x80000
    s_mul_i32 s99, s99, 0x2001
    s_and_b32 s99, s99, 0x00070007
    s_bfe_u32 s100, s60, 0x80008
    s_mul_i32 s100, s100, 0x2001
    s_and_b32 s100, s100, 0x00070007
    s_bfe_u32 s101, s60, 0x80010
    s_mul_i32 s101, s101, 0x2001
    s_and_b32 s101, s101, 0x00070007
    s_mov_b32 s3, 0x000f000f
L_g0:
    ds_read_b32 v29, v31 offset:8
    s_waitcnt lgkmcnt(0)
    v_cmp_gt_u32 vcc, 4, v29
    s_and_b64 exec, exec, vcc
    s_cbranch_scc0 L_g0_done
    s_sleep 2
    s_add_u32 s63, s63, 1
    s_cmp_lt_u32 s63, 1048576
    s_cbranch_scc1 L_g0
L_g0_done:
    s_mov_b64 exec, -1
    s_mov_b64 exec, 1
    s_lshl_b32 s58, s64, 20
    v_mov_b32 v41, s58
    global_load_dword v30, v41, s[8:9]
    s_mov_b64 exec, -1
    s_atomic_add_x2 s[44:45], s[36:37], 0
    s_mov_b32 s20, 1
    s_atomic_add s20, s[66:67], 0 glc
    s_waitcnt lgkmcnt(0)
    s_sub_u32 s58, s20, s24
    s_mov_b32 s16, 0
    s_cmp_ge_u32 s58, 36
    s_cselect_b32 s16, 1, s16
    s_cmp_ge_u32 s58, 54
    s_cselect_b32 s16, 2, s16
    v_mov_b32 v11, s16
    ds_write_b32 v31, v11 offset:20
    s_cmp_lg_u32 s65, 0
    s_cbranch_scc1 L_noq
    v_add_u32 v27, 0, v25
    v_lshlrev_b32 v28, 1, v26
    v_xor_b32 v28, v28, v27
    v_lshlrev_b32 v28, 4, v28
    v_lshl_or_b32 v28, v27, 9, v28
    v_add_u32 v12, 24576, v28
    v_xor_b32 v13, 16, v12
    v_add_u32 v14, 0x10000, v12
    v_add_u32 v15, 0x10000, v13
    v_add_u32 v27, 4, v25
    v_lshlrev_b32 v28, 1, v26
    v_xor_b32 v28, v28, v27
    v_lshlrev_b32 v28, 4, v28
    v_lshl_or_b32 v28, v27, 9, v28
    v_add_u32 v16, 24576, v28
    v_xor_b32 v17, 16, v16
    v_add_u32 v18, 0x10000, v16
    v_add_u32 v19, 0x10000, v17
    v_lshlrev_b32 v3, 4, v26
    v_lshl_or_b32 v3, v25, 14, v3
    s_lshr_b32 s59, s2, 5
    s_add_u32 s57, s53, s59
    s_and_b32 s57, s57, 3
    s_lshl_b32 s57, s57, 3
    s_add_u32 s57, s57, s59
    s_lshr_b32 s59, s53, 2
    s_lshl_b32 s59, s59, 11
    s_lshr_b32 s58, s57, 3
    s_lshl_b32 s58, s58, 12
    s_add_u32 s59, s59, s58
    s_and_b32 s57, s57, 7
    s_lshl_b32 s57, s57, 8
    s_add_u32 s57, s57, s59
    s_add_u32 s57, s57, 2097152
L_qpw:
    ds_read_b32 v29, v31 offset:4
    s_waitcnt lgkmcnt(0)
    v_cmp_gt_u32 vcc, 4, v29
    s_and_b64 exec, exec, vcc
    s_cbranch_scc0 L_qpw_done
    s_sleep 2
    s_add_u32 s63, s63, 1
    s_cmp_lt_u32 s63, 1048576
    s_cbranch_scc1 L_qpw
L_qpw_done:
    s_mov_b64 exec, -1
    ds_read_b128 v[64:67], v12 offset:0
    ds_read_b128 v[68:71], v13 offset:0
    ds_read_b128 v[72:75], v12 offset:32768
    ds_read_b128 v[76:79], v13 offset:32768
    ds_read_b128 v[80:83], v14 offset:0
    ds_read_b128 v[84:87], v15 offset:0
    ds_read_b128 v[88:91], v14 offset:32768
    ds_read_b128 v[92:95], v15 offset:32768
    ds_read_b128 v[96:99], v16 offset:0
    ds_read_b128 v[100:103], v17 offset:0
    ds_read_b128 v[104:107], v16 offset:32768
    ds_read_b128 v[108:111], v17 offset:32768
    ds_read_b128 v[112:115], v18 offset:0
    ds_read_b128 v[116:119], v19 offset:0
    ds_read_b128 v[120:123], v18 offset:32768
    ds_read_b128 v[124:127], v19 offset:32768
    ds_read_b128 v[128:131], v12 offset:4096
    ds_read_b128 v[132:135], v13 offset:4096
    ds_read_b128 v[136:139], v12 offset:36864
    ds_read_b128 v[140:143], v13 offset:36864
    ds_read_b128 v[144:147], v14 offset:4096
    ds_read_b128 v[148:151], v15 offset:4096
    ds_read_b128 v[152:155], v14 offset:36864
    ds_read_b128 v[156:159], v15 offset:36864
    ds_read_b128 v[160:163], v16 offset:4096
    ds_read_b128 v[164:167], v17 offset:4096
    ds_read_b128 v[168:171], v16 offset:36864
    ds_read_b128 v[172:175], v17 offset:36864
    ds_read_b128 v[176:179], v18 offset:4096
    ds_read_b128 v[180:183], v19 offset:4096
    ds_read_b128 v[184:187], v18 offset:36864
    ds_read_b128 v[188:191], v19 offset:36864
    s_waitcnt lgkmcnt(0)
    v_pk_add_f32 v[64:65], v[64:65], v[72:73]
    v_pk_add_f32 v[80:81], v[80:81], v[88:89]
    v_pk_add_f32 v[66:67], v[66:67], v[74:75]
    v_pk_add_f32 v[82:83], v[82:83], v[90:91]
    v_pk_add_f32 v[68:69], v[68:69], v[76:77]
    v_pk_add_f32 v[84:85], v[84:85], v[92:93]
    v_pk_add_f32 v[70:71], v[70:71], v[78:79]
    v_pk_add_f32 v[86:87], v[86:87], v[94:95]
    v_pk_add_f32 v[64:65], v[64:65], v[80:81]
    v_pk_add_f32 v[66:67], v[66:67], v[82:83]
    v_pk_add_f32 v[68:69], v[68:69], v[84:85]
    v_pk_add_f32 v[70:71], v[70:71], v[86:87]
    v_max3_f32 v20, |v64|, |v65|, |v66|
    v_max3_f32 v21, |v68|, |v69|, |v70|
    v_max3_f32 v20, v20, |v67|, |v71|
    v_max_f32 v20, v20, v21
    v_and_b32 v21, 0x7f800000, v20
    v_sub_u32 v20, 0x7e800100, v21
    v_lshrrev_b32 v21, 23, v21
    v_sub_u32 v21, v21, 14 clamp
    v_pk_fma_f32 v[64:65], v[64:65], v[20:21], v[4:5] op_sel_hi:[1,0,0]
    v_pk_fma_f32 v[66:67], v[66:67], v[20:21], v[6:7] op_sel_hi:[1,0,0]
    v_pk_fma_f32 v[68:69], v[68:69], v[20:21], v[6:7] op_sel_hi:[1,0,0]
    v_pk_fma_f32 v[70:71], v[70:71], v[20:21], v[6:7] op_sel_hi:[1,0,0]
    v_mul_u32_u24 v21, 0x1001, v21
    v_cvt_pknorm_i16_f32 v72, v64, v65
    v_cvt_pknorm_i16_f32 v73, v66, v67
    v_cvt_pknorm_i16_f32 v74, v68, v69
    v_cvt_pknorm_i16_f32 v75, v70, v71
    v_bfi_b32 v72, s3, v21, v72
    v_bfi_b32 v73, v5, s99, v73
    v_bfi_b32 v74, v5, s100, v74
    v_bfi_b32 v75, v5, s101, v75
    buffer_store_dwordx4 v[72:75], v3, s[40:43], s57 offen sc1
    s_add_u32 s57, s57, 0x10000
    v_pk_add_f32 v[96:97], v[96:97], v[104:105]
    v_pk_add_f32 v[112:113], v[112:113], v[120:121]
    v_pk_add_f32 v[98:99], v[98:99], v[106:107]
    v_pk_add_f32 v[114:115], v[114:115], v[122:123]
    v_pk_add_f32 v[100:101], v[100:101], v[108:109]
    v_pk_add_f32 v[116:117], v[116:117], v[124:125]
    v_pk_add_f32 v[102:103], v[102:103], v[110:111]
    v_pk_add_f32 v[118:119], v[118:119], v[126:127]
    v_pk_add_f32 v[96:97], v[96:97], v[112:113]
    v_pk_add_f32 v[98:99], v[98:99], v[114:115]
    v_pk_add_f32 v[100:101], v[100:101], v[116:117]
    v_pk_add_f32 v[102:103], v[102:103], v[118:119]
    v_max3_f32 v20, |v96|, |v97|, |v98|
    v_max3_f32 v21, |v100|, |v101|, |v102|
    v_max3_f32 v20, v20, |v99|, |v103|
    v_max_f32 v20, v20, v21
    v_and_b32 v21, 0x7f800000, v20
    v_sub_u32 v20, 0x7e800100, v21
    v_lshrrev_b32 v21, 23, v21
    v_sub_u32 v21, v21, 14 clamp
    v_pk_fma_f32 v[96:97], v[96:97], v[20:21], v[4:5] op_sel_hi:[1,0,0]
    v_pk_fma_f32 v[98:99], v[98:99], v[20:21], v[6:7] op_sel_hi:[1,0,0]
    v_pk_fma_f32 v[100:101], v[100:101], v[20:21], v[6:7] op_sel_hi:[1,0,0]
    v_pk_fma_f32 v[102:103], v[102:103], v[20:21], v[6:7] op_sel_hi:[1,0,0]
    v_mul_u32_u24 v21, 0x1001, v21
    v_cvt_pknorm_i16_f32 v104, v96, v97
    v_cvt_pknorm_i16_f32 v105, v98, v99
    v_cvt_pknorm_i16_f32 v106, v100, v101
    v_cvt_pknorm_i16_f32 v107, v102, v103
    v_bfi_b32 v104, s3, v21, v104
    v_bfi_b32 v105, v5, s99, v105
    v_bfi_b32 v106, v5, s100, v106
    v_bfi_b32 v107, v5, s101, v107
    buffer_store_dwordx4 v[104:107], v3, s[40:43], s57 offen sc1
    s_add_u32 s57, s57, 0x10000
    v_pk_add_f32 v[128:129], v[128:129], v[136:137]
    v_pk_add_f32 v[144:145], v[144:145], v[152:153]
    v_pk_add_f32 v[130:131], v[130:131], v[138:139]
    v_pk_add_f32 v[146:147], v[146:147], v[154:155]
    v_pk_add_f32 v[132:133], v[132:133], v[140:141]
    v_pk_add_f32 v[148:149], v[148:149], v[156:157]
    v_pk_add_f32 v[134:135], v[134:135], v[142:143]
    v_pk_add_f32 v[150:151], v[150:151], v[158:159]
    v_pk_add_f32 v[128:129], v[128:129], v[144:145]
    v_pk_add_f32 v[130:131], v[130:131], v[146:147]
    v_pk_add_f32 v[132:133], v[132:133], v[148:149]
    v_pk_add_f32 v[134:135], v[134:135], v[150:151]
    v_max3_f32 v20, |v128|, |v129|, |v130|
    v_max3_f32 v21, |v132|, |v133|, |v134|
    v_max3_f32 v20, v20, |v131|, |v135|
    v_max_f32 v20, v20, v21
    v_and_b32 v21, 0x7f800000, v20
    v_sub_u32 v20, 0x7e800100, v21
    v_lshrrev_b32 v21, 23, v21
    v_sub_u32 v21, v21, 14 clamp
    v_pk_fma_f32 v[128:129], v[128:129], v[20:21], v[4:5] op_sel_hi:[1,0,0]
    v_pk_fma_f32 v[130:131], v[130:131], v[20:21], v[6:7] op_sel_hi:[1,0,0]
    v_pk_fma_f32 v[132:133], v[132:133], v[20:21], v[6:7] op_sel_hi:[1,0,0]
    v_pk_fma_f32 v[134:135], v[134:135], v[20:21], v[6:7] op_sel_hi:[1,0,0]
    v_mul_u32_u24 v21, 0x1001, v21
    v_cvt_pknorm_i16_f32 v136, v128, v129
    v_cvt_pknorm_i16_f32 v137, v130, v131
    v_cvt_pknorm_i16_f32 v138, v132, v133
    v_cvt_pknorm_i16_f32 v139, v134, v135
    v_bfi_b32 v136, s3, v21, v136
    v_bfi_b32 v137, v5, s99, v137
    v_bfi_b32 v138, v5, s100, v138
    v_bfi_b32 v139, v5, s101, v139
    buffer_store_dwordx4 v[136:139], v3, s[40:43], s57 offen sc1
    s_add_u32 s57, s57, 0x10000
    v_pk_add_f32 v[160:161], v[160:161], v[168:169]
    v_pk_add_f32 v[176:177], v[176:177], v[184:185]
    v_pk_add_f32 v[162:163], v[162:163], v[170:171]
    v_pk_add_f32 v[178:179], v[178:179], v[186:187]
    v_pk_add_f32 v[164:165], v[164:165], v[172:173]
    v_pk_add_f32 v[180:181], v[180:181], v[188:189]
    v_pk_add_f32 v[166:167], v[166:167], v[174:175]
    v_pk_add_f32 v[182:183], v[182:183], v[190:191]
    v_pk_add_f32 v[160:161], v[160:161], v[176:177]
    v_pk_add_f32 v[162:163], v[162:163], v[178:179]
    v_pk_add_f32 v[164:165], v[164:165], v[180:181]
    v_pk_add_f32 v[166:167], v[166:167], v[182:183]
    v_max3_f32 v20, |v160|, |v161|, |v162|
    v_max3_f32 v21, |v164|, |v165|, |v166|
    v_max3_f32 v20, v20, |v163|, |v167|
    v_max_f32 v20, v20, v21
    v_and_b32 v21, 0x7f800000, v20
    v_sub_u32 v20, 0x7e800100, v21
    v_lshrrev_b32 v21, 23, v21
    v_sub_u32 v21, v21, 14 clamp
    v_pk_fma_f32 v[160:161], v[160:161], v[20:21], v[4:5] op_sel_hi:[1,0,0]
    v_pk_fma_f32 v[162:163], v[162:163], v[20:21], v[6:7] op_sel_hi:[1,0,0]
    v_pk_fma_f32 v[164:165], v[164:165], v[20:21], v[6:7] op_sel_hi:[1,0,0]
    v_pk_fma_f32 v[166:167], v[166:167], v[20:21], v[6:7] op_sel_hi:[1,0,0]
    v_mul_u32_u24 v21, 0x1001, v21
    v_cvt_pknorm_i16_f32 v168, v160, v161
    v_cvt_pknorm_i16_f32 v169, v162, v163
    v_cvt_pknorm_i16_f32 v170, v164, v165
    v_cvt_pknorm_i16_f32 v171, v166, v167
    v_bfi_b32 v168, s3, v21, v168
    v_bfi_b32 v169, v5, s99, v169
    v_bfi_b32 v170, v5, s100, v170
    v_bfi_b32 v171, v5, s101, v171
    buffer_store_dwordx4 v[168:171], v3, s[40:43], s57 offen sc1
L_noq:
L_g1:
    ds_read_b32 v29, v31 offset:8
    s_waitcnt lgkmcnt(0)
    v_cmp_gt_u32 vcc, 8, v29
    s_and_b64 exec, exec, vcc
    s_cbranch_scc0 L_g1_done
    s_sleep 2
    s_add_u32 s63, s63, 1
    s_cmp_lt_u32 s63, 1048576
    s_cbranch_scc1 L_g1
L_g1_done:
    s_mov_b64 exec, -1
    s_mov_b32 s20, 1
    s_atomic_add s20, s[66:67], 256 glc
    s_lshl_b32 s57, s64, 12
    s_add_u32 s57, s57, 2097152
L_q:
    buffer_load_dwordx4 v[32:35], v2, s[40:43], s57 offen offset:0 sc1
    buffer_load_dwordx4 v[36:39], v2, s[40:43], s57 offen offset:1024 sc1
    buffer_load_dwordx4 v[40:43], v2, s[40:43], s57 offen offset:2048 sc1
    buffer_load_dwordx4 v[44:47], v2, s[40:43], s57 offen offset:3072 sc1
    s_waitcnt vmcnt(0)
    v_xor_b32 v33, s99, v33
    v_xor_b32 v34, s100, v34
    v_xor_b32 v35, s101, v35
    v_xor_b32 v37, s99, v37
    v_xor_b32 v38, s100, v38
    v_xor_b32 v39, s101, v39
    v_xor_b32 v41, s99, v41
    v_xor_b32 v42, s100, v42
    v_xor_b32 v43, s101, v43
    v_xor_b32 v45, s99, v45
    v_xor_b32 v46, s100, v46
    v_xor_b32 v47, s101, v47
    v_or3_b32 v20, v33, v34, v35
    v_or3_b32 v20, v20, v37, v38
    v_or3_b32 v20, v20, v39, v41
    v_or3_b32 v20, v20, v42, v43
    v_or3_b32 v20, v20, v45, v46
    v_or_b32 v20, v20, v47
    v_and_b32 v20, 0x00070007, v20
    v_cmp_ne_u32 vcc, 0, v20
    s_wqm_b64 exec, vcc
    s_cbranch_scc0 L_q_done
    s_sleep 8
    s_add_u32 s63, s63, 1
    s_cmp_lt_u32 s63, 1048576
    s_cbranch_scc1 L_q
L_q_done:
    s_mov_b64 exec, -1
    v_add_u32 v12, 147968, v2
    v_and_b32 v21, s3, v32
    v_mul_u32_u24 v20, 0x800800, v21
    v_xor_b32 v32, v32, v21
    v_and_b32 v20, 0x7f800000, v20
    v_cvt_f32_i32_sdwa v64, sext(v32) dst_sel:DWORD dst_unused:UNUSED_PAD src0_sel:WORD_0
    v_cvt_f32_i32_sdwa v65, sext(v32) dst_sel:DWORD dst_unused:UNUSED_PAD src0_sel:WORD_1
    v_cvt_f32_i32_sdwa v66, sext(v33) dst_sel:DWORD dst_unused:UNUSED_PAD src0_sel:WORD_0
    v_cvt_f32_i32_sdwa v67, sext(v33) dst_sel:DWORD dst_unused:UNUSED_PAD src0_sel:WORD_1
    v_cvt_f32_i32_sdwa v68, sext(v34) dst_sel:DWORD dst_unused:UNUSED_PAD src0_sel:WORD_0
    v_cvt_f32_i32_sdwa v69, sext(v34) dst_sel:DWORD dst_unused:UNUSED_PAD src0_sel:WORD_1
    v_cvt_f32_i32_sdwa v70, sext(v35) dst_sel:DWORD dst_unused:UNUSED_PAD src0_sel:WORD_0
    v_cvt_f32_i32_sdwa v71, sext(v35) dst_sel:DWORD dst_unused:UNUSED_PAD src0_sel:WORD_1
    v_pk_mul_f32 v[48:49], v[64:65], v[20:21] op_sel:[0,0] op_sel_hi:[1,0]
    v_pk_mul_f32 v[50:51], v[66:67], v[20:21] op_sel:[0,0] op_sel_hi:[1,0]
    v_pk_mul_f32 v[52:53], v[68:69], v[20:21] op_sel:[0,0] op_sel_hi:[1,0]
    v_pk_mul_f32 v[54:55], v[70:71], v[20:21] op_sel:[0,0] op_sel_hi:[1,0]
    v_and_b32 v21, s3, v40
    v_mul_u32_u24 v20, 0x800800, v21
    v_xor_b32 v40, v40, v21
    v_and_b32 v20, 0x7f800000, v20
    v_cvt_f32_i32_sdwa v64, sext(v40) dst_sel:DWORD dst_unused:UNUSED_PAD src0_sel:WORD_0
    v_cvt_f32_i32_sdwa v65, sext(v40) dst_sel:DWORD dst_unused:UNUSED_PAD src0_sel:WORD_1
    v_cvt_f32_i32_sdwa v66, sext(v41) dst_sel:DWORD dst_unused:UNUSED_PAD src0_sel:WORD_0
    v_cvt_f32_i32_sdwa v67, sext(v41) dst_sel:DWORD dst_unused:UNUSED_PAD src0_sel:WORD_1
    v_cvt_f32_i32_sdwa v68, sext(v42) dst_sel:DWORD dst_unused:UNUSED_PAD src0_sel:WORD_0
    v_cvt_f32_i32_sdwa v69, sext(v42) dst_sel:DWORD dst_unused:UNUSED_PAD src0_sel:WORD_1
    v_cvt_f32_i32_sdwa v70, sext(v43) dst_sel:DWORD dst_unused:UNUSED_PAD src0_sel:WORD_0
    v_cvt_f32_i32_sdwa v71, sext(v43) dst_sel:DWORD dst_unused:UNUSED_PAD src0_sel:WORD_1
    v_pk_fma_f32 v[48:49], v[64:65], v[20:21], v[48:49] op_sel:[0,0,0] op_sel_hi:[1,0,1]
    v_pk_fma_f32 v[50:51], v[66:67], v[20:21], v[50:51] op_sel:[0,0,0] op_sel_hi:[1,0,1]
    v_pk_fma_f32 v[52:53], v[68:69], v[20:21], v[52:53] op_sel:[0,0,0] op_sel_hi:[1,0,1]
    v_pk_fma_f32 v[54:55], v[70:71], v[20:21], v[54:55] op_sel:[0,0,0] op_sel_hi:[1,0,1]
    v_cvt_pk_bf16_f32 v48, v48, v49
    v_cvt_pk_bf16_f32 v49, v50, v51
    v_cvt_pk_bf16_f32 v50, v52, v53
    v_cvt_pk_bf16_f32 v51, v54, v55
    ds_write_b128 v12, v[48:51] offset:0
    v_and_b32 v21, s3, v36
    v_mul_u32_u24 v20, 0x800800, v21
    v_xor_b32 v36, v36, v21
    v_and_b32 v20, 0x7f800000, v20
    v_cvt_f32_i32_sdwa v64, sext(v36) dst_sel:DWORD dst_unused:UNUSED_PAD src0_sel:WORD_0
    v_cvt_f32_i32_sdwa v65, sext(v36) dst_sel:DWORD dst_unused:UNUSED_PAD src0_sel:WORD_1
    v_cvt_f32_i32_sdwa v66, sext(v37) dst_sel:DWORD dst_unused:UNUSED_PAD src0_sel:WORD_0
    v_cvt_f32_i32_sdwa v67, sext(v37) dst_sel:DWORD dst_unused:UNUSED_PAD src0_sel:WORD_1
    v_cvt_f32_i32_sdwa v68, sext(v38) dst_sel:DWORD dst_unused:UNUSED_PAD src0_sel:WORD_0
    v_cvt_f32_i32_sdwa v69, sext(v38) dst_sel:DWORD dst_unused:UNUSED_PAD src0_sel:WORD_1
    v_cvt_f32_i32_sdwa v70, sext(v39) dst_sel:DWORD dst_unused:UNUSED_PAD src0_sel:WORD_0
    v_cvt_f32_i32_sdwa v71, sext(v39) dst_sel:DWORD dst_unused:UNUSED_PAD src0_sel:WORD_1
    v_pk_mul_f32 v[56:57], v[64:65], v[20:21] op_sel:[0,0] op_sel_hi:[1,0]
    v_pk_mul_f32 v[58:59], v[66:67], v[20:21] op_sel:[0,0] op_sel_hi:[1,0]
    v_pk_mul_f32 v[60:61], v[68:69], v[20:21] op_sel:[0,0] op_sel_hi:[1,0]
    v_pk_mul_f32 v[62:63], v[70:71], v[20:21] op_sel:[0,0] op_sel_hi:[1,0]
    v_and_b32 v21, s3, v44
    v_mul_u32_u24 v20, 0x800800, v21
    v_xor_b32 v44, v44, v21
    v_and_b32 v20, 0x7f800000, v20
    v_cvt_f32_i32_sdwa v64, sext(v44) dst_sel:DWORD dst_unused:UNUSED_PAD src0_sel:WORD_0
    v_cvt_f32_i32_sdwa v65, sext(v44) dst_sel:DWORD dst_unused:UNUSED_PAD src0_sel:WORD_1
    v_cvt_f32_i32_sdwa v66, sext(v45) dst_sel:DWORD dst_unused:UNUSED_PAD src0_sel:WORD_0
    v_cvt_f32_i32_sdwa v67, sext(v45) dst_sel:DWORD dst_unused:UNUSED_PAD src0_sel:WORD_1
    v_cvt_f32_i32_sdwa v68, sext(v46) dst_sel:DWORD dst_unused:UNUSED_PAD src0_sel:WORD_0
    v_cvt_f32_i32_sdwa v69, sext(v46) dst_sel:DWORD dst_unused:UNUSED_PAD src0_sel:WORD_1
    v_cvt_f32_i32_sdwa v70, sext(v47) dst_sel:DWORD dst_unused:UNUSED_PAD src0_sel:WORD_0
    v_cvt_f32_i32_sdwa v71, sext(v47) dst_sel:DWORD dst_unused:UNUSED_PAD src0_sel:WORD_1
    v_pk_fma_f32 v[56:57], v[64:65], v[20:21], v[56:57] op_sel:[0,0,0] op_sel_hi:[1,0,1]
    v_pk_fma_f32 v[58:59], v[66:67], v[20:21], v[58:59] op_sel:[0,0,0] op_sel_hi:[1,0,1]
    v_pk_fma_f32 v[60:61], v[68:69], v[20:21], v[60:61] op_sel:[0,0,0] op_sel_hi:[1,0,1]
    v_pk_fma_f32 v[62:63], v[70:71], v[20:21], v[62:63] op_sel:[0,0,0] op_sel_hi:[1,0,1]
    v_cvt_pk_bf16_f32 v56, v56, v57
    v_cvt_pk_bf16_f32 v57, v58, v59
    v_cvt_pk_bf16_f32 v58, v60, v61
    v_cvt_pk_bf16_f32 v59, v62, v63
    ds_write_b128 v12, v[56:59] offset:1024
    v_mov_b32 v14, 1
    ds_write_b32 v31, v8 offset:16
    ds_write_b32 v31, v14
    s_waitcnt lgkmcnt(0)
    s_sub_u32 s58, s20, s25
    s_mov_b32 s16, 0
    s_cmp_ge_u32 s58, 36
    s_cselect_b32 s16, 1, s16
    s_cmp_ge_u32 s58, 54
    s_cselect_b32 s16, 2, s16
    v_mov_b32 v11, s16
    ds_write_b32 v31, v11 offset:20
    v_and_b32 v12, 31, v1
    v_lshlrev_b32 v13, 3, v12
    v_add_u32 v13, 154240, v13
    v_lshlrev_b32 v14, 4, v12
L_g2:
    ds_read_b32 v29, v31 offset:8
    s_waitcnt lgkmcnt(0)
    v_cmp_gt_u32 vcc, 12, v29
    s_and_b64 exec, exec, vcc
    s_cbranch_scc0 L_g2_done
    s_sleep 2
    s_add_u32 s63, s63, 1
    s_cmp_lt_u32 s63, 1048576
    s_cbranch_scc1 L_g2
L_g2_done:
    s_mov_b64 exec, -1
    s_mov_b32 s20, 1
    s_atomic_add s20, s[66:67], 512 glc
    s_waitcnt lgkmcnt(0)
    s_sub_u32 s58, s20, s26
    s_mov_b32 s16, 0
    s_cmp_ge_u32 s58, 36
    s_cselect_b32 s16, 1, s16
    s_cmp_ge_u32 s58, 54
    s_cselect_b32 s16, 2, s16
    v_mov_b32 v11, s16
    ds_write_b32 v31, v11 offset:20
L_sw:
    ds_read_b32 v29, v31 offset:12
    s_waitcnt lgkmcnt(0)
    v_cmp_gt_u32 vcc, 4, v29
    s_and_b64 exec, exec, vcc
    s_cbranch_scc0 L_sw_done
    s_sleep 4
    s_add_u32 s63, s63, 1
    s_cmp_lt_u32 s63, 1048576
    s_cbranch_scc1 L_sw
L_sw_done:
    s_mov_b64 exec, -1
    ds_read_b64 v[16:17], v13
    s_waitcnt lgkmcnt(0)
    v_mov_b32 v20, v16
    s_nop 1
    v_max_f32_dpp v20, v20, v20 row_ror:8 row_mask:0xf bank_mask:0xf
    v_mov_b32 v24, v20
    s_nop 1
    v_permlane16_swap_b32 v20, v24
    v_max_f32 v20, v20, v24
    v_sub_f32 v22, v16, v20
    v_mul_f32 v22, s62, v22
    v_exp_f32 v22, v22
    s_nop 0
    v_mul_f32 v22, v22, v17
    s_nop 1
    v_add_f32_dpp v22, v22, v22 row_ror:8 row_mask:0xf bank_mask:0xf
    v_mov_b32 v24, v22
    s_nop 1
    v_permlane16_swap_b32 v22, v24
    v_add_f32 v22, v22, v24
    v_mov_b32 v21, v8
    v_mov_b32 v23, v8
    s_lshl_b32 s57, s64, 9
    s_add_u32 s57, s57, 2359296
    s_lshl_b32 s58, s65, 7
    s_add_u32 s58, s58, s57
    s_mov_b64 exec, 0xff
    buffer_store_dwordx4 v[20:23], v14, s[40:43], s58 offen sc1
    s_mov_b64 exec, -1
L_g3:
    ds_read_b32 v29, v31 offset:8
    s_waitcnt lgkmcnt(0)
    v_cmp_gt_u32 vcc, 16, v29
    s_and_b64 exec, exec, vcc
    s_cbranch_scc0 L_g3_done
    s_sleep 2
    s_add_u32 s63, s63, 1
    s_cmp_lt_u32 s63, 1048576
    s_cbranch_scc1 L_g3
L_g3_done:
    s_mov_b64 exec, -1
    s_mov_b32 s20, 1
    s_atomic_add s20, s[66:67], 768 glc
    s_waitcnt lgkmcnt(0)
    s_sub_u32 s58, s20, s27
    s_mov_b32 s16, 0
    s_cmp_ge_u32 s58, 36
    s_cselect_b32 s16, 1, s16
    s_cmp_ge_u32 s58, 54
    s_cselect_b32 s16, 2, s16
    v_mov_b32 v11, s16
    ds_write_b32 v31, v11 offset:20
    s_mul_i32 s58, s53, 4352
    s_add_u32 s58, s58, 2527232
    buffer_load_dwordx2 v[36:37], v9, s[40:43], s58 offen sc1
L_st:
    buffer_load_dwordx4 v[32:35], v14, s[40:43], s57 offen sc1
    s_waitcnt vmcnt(0)
    v_xor_b32 v33, v8, v33
    v_xor_b32 v35, v8, v35
    v_or_b32 v33, v33, v35
    v_cmp_ne_u32 vcc, 0, v33
    s_and_b64 exec, exec, vcc
    s_cbranch_scc0 L_st_done
    s_sleep 16
    s_add_u32 s63, s63, 1
    s_cmp_lt_u32 s63, 1048576
    s_cbranch_scc1 L_st
L_st_done:
    s_mov_b64 exec, -1
    v_readfirstlane_b32 s22, v36
    v_readfirstlane_b32 s23, v37
    s_sub_u32 s22, s22, s38
    s_subb_u32 s23, s23, s39
    s_cmp_eq_u64 s[22:23], s[46:47]
    s_cselect_b32 s17, 1, 0
    v_mov_b32 v11, s17
    ds_write_b32 v31, v11 offset:28
    v_mov_b32 v20, v32
    s_nop 1
    v_max_f32_dpp v20, v20, v20 row_ror:8 row_mask:0xf bank_mask:0xf
    v_mov_b32 v24, v20
    s_nop 1
    v_permlane16_swap_b32 v20, v24
    v_max_f32 v20, v20, v24
    v_sub_f32 v21, v32, v20
    v_mul_f32 v21, s62, v21
    v_exp_f32 v21, v21
    s_nop 0
    v_mul_f32 v21, v21, v34
    s_nop 1
    v_add_f32_dpp v21, v21, v21 row_ror:8 row_mask:0xf bank_mask:0xf
    v_mov_b32 v24, v21
    s_nop 1
    v_permlane16_swap_b32 v21, v24
    v_add_f32 v21, v21, v24
    v_rcp_f32 v21, v21
    v_sub_f32 v20, v16, v20
    v_mul_f32 v20, s62, v20
    v_exp_f32 v20, v20
    v_and_b32 v26, 7, v1
    v_mul_f32 v20, v20, v21
    v_bfe_u32 v27, v1, 3, 2
    v_lshlrev_b32 v27, 2, v27
    v_lshl_or_b32 v26, v26, 4, v27
    v_add_u32 v26, 154112, v26
    ds_write_b32 v26, v20
    s_waitcnt lgkmcnt(0)
L_g4:
    ds_read_b32 v29, v31 offset:8
    s_waitcnt lgkmcnt(0)
    v_cmp_gt_u32 vcc, 20, v29
    s_and_b64 exec, exec, vcc
    s_cbranch_scc0 L_g4_done
    s_sleep 2
    s_add_u32 s63, s63, 1
    s_cmp_lt_u32 s63, 1048576
    s_cbranch_scc1 L_g4
L_g4_done:
    s_mov_b64 exec, -1
    s_mov_b32 s20, 1
    s_atomic_add s20, s[66:67], 1024 glc
    s_waitcnt lgkmcnt(0)
    s_sub_u32 s58, s20, s28
    s_mov_b32 s16, 0
    s_cmp_ge_u32 s58, 36
    s_cselect_b32 s16, 1, s16
    s_cmp_ge_u32 s58, 54
    s_cselect_b32 s16, 2, s16
    v_mov_b32 v11, s16
    ds_write_b32 v31, v11 offset:20
L_end:
L_last:
    s_endpgm
.section .rodata,"a"
.p2align 6
.amdhsa_kernel standalone__gqa_block_cached__sampling_kernel
  .amdhsa_next_free_vgpr 256
  .amdhsa_next_free_sgpr 102
  .amdhsa_accum_offset 256
  .amdhsa_group_segment_fixed_size 0
  .amdhsa_kernarg_size 64
  .amdhsa_user_sgpr_count 2
  .amdhsa_user_sgpr_kernarg_segment_ptr 1
  .amdhsa_system_sgpr_workgroup_id_x 1
.end_amdhsa_kernel
```
